```python
import torch

def _softmax(x, axis=-1):
    return torch.softmax(x, dim=axis)
def _gelu(x):
    return torch.nn.functional.gelu(x, approximate="tanh")
def _silu(x):
    return torch.nn.functional.silu(x)
def _sigmoid(x):
    return torch.sigmoid(x)
def _layernorm(x, axis=-1, eps=1e-5):
    m = x.mean(dim=axis, keepdim=True)
    v = x.var(dim=axis, keepdim=True, unbiased=False)
    return (x - m) / torch.sqrt(v + eps)
def _scatter_add(tgt, idx, src, axis=0):
    return tgt.clone().index_add_(axis, idx, src)
def _segment_sum(src, seg, n):
    out = torch.zeros((n,) + src.shape[1:], dtype=src.dtype)
    return out.index_add_(0, seg, src)
def _pad(x, pw):
    flat = tuple(v for pair in reversed(pw) for v in pair)
    return torch.nn.functional.pad(x, flat)

kernel_name = 'recurrent_scan__grouped_kv_mqa__moe_arch_mod__prompt'

def setup_inputs():

    _w = (lambda a: (lambda t: t.to(torch.bfloat16) if t.is_floating_point() else t)(torch.as_tensor(a)))
    def _A_setup():
        B, S, D, H = 1, 2048, 512, 32
        Dh = D // H
        return {
            "x": _w((lambda *s: torch.randn(*s, dtype=torch.bfloat16) * 0.05)(B, S, D)),
            "wq": _w((lambda *s: torch.randn(*s, dtype=torch.bfloat16) * 0.05)(D, H * Dh)),
            "wk": _w((lambda *s: torch.randn(*s, dtype=torch.bfloat16) * 0.05)(D, Dh)),
            "wv": _w((lambda *s: torch.randn(*s, dtype=torch.bfloat16) * 0.05)(D, Dh)),
            "wo": _w((lambda *s: torch.randn(*s, dtype=torch.bfloat16) * 0.05)(H * Dh, D)),
        }
    _A_in = _A_setup()

    def _B_setup():
        B, S, D, F, C = 1, 2048, 512, 1792, 2
        return {
            "x": _w((lambda *s: torch.randn(*s, dtype=torch.bfloat16) * 0.05)(B, S, D)),
            "w_r": _w((lambda *s: torch.randn(*s, dtype=torch.bfloat16) * 1.6)(D)),
            "w_gate": _w((lambda *s: torch.randn(*s, dtype=torch.bfloat16) * 0.1)(D, F)),
            "w_up": _w((lambda *s: torch.randn(*s, dtype=torch.bfloat16) * 0.1)(D, F)),
            "w_down": _w((lambda *s: torch.randn(*s, dtype=torch.bfloat16) * 0.1)(F, D)),
        }
    _B_in = _B_setup()

    return {
        "A_x": _A_in["x"],
        "A_wq": _A_in["wq"],
        "A_wk": _A_in["wk"],
        "A_wv": _A_in["wv"],
        "A_wo": _A_in["wo"],
        "B_x": _B_in["x"],
        "B_w_r": _B_in["w_r"],
        "B_w_gate": _B_in["w_gate"],
        "B_w_up": _B_in["w_up"],
        "B_w_down": _B_in["w_down"],
    }

def reference(A_x, A_wq, A_wk, A_wv, A_wo, B_x, B_w_r, B_w_gate, B_w_up, B_w_down):
    def _A_ref(x, wq, wk, wv, wo):
        B, S, D = x.shape
        H = 32
        Dh = D // H
        q = (lambda x, *d: x.permute(*d))((x @ wq).reshape(B, S, H, Dh), 0, 2, 1, 3)
        k = x @ wk
        v = x @ wv
        scores = torch.einsum("bhqd,bkd->bhqk", q, k) * (Dh ** -0.5)
        p = _softmax(scores, axis=-1)
        o = torch.einsum("bhqk,bkd->bhqd", p, v)
        return (lambda x, *d: x.permute(*d))(o, 0, 2, 1, 3).reshape(B, S, H * Dh) @ wo

    def _B_ref(x, w_r, w_gate, w_up, w_down):
        B, S, D = x.shape
        C = 2
        r = x @ w_r
        idx = torch.argsort(-r, axis=-1)[:, :C]
        idx_e = (lambda x, n, axis: torch.repeat_interleave(x, n, dim=axis))(idx.reshape(B, C, 1), D, axis=2)
        x_sel = (lambda x, i, axis: torch.take_along_dim(x, i, dim=axis))(x, idx_e, axis=1)
        g = _silu(x_sel @ w_gate)
        u = x_sel @ w_up
        y = (g * u) @ w_down
        r_sel = _sigmoid((lambda x, i, axis: torch.take_along_dim(x, i, dim=axis))(r, idx, axis=1))
        y = y * r_sel.reshape(B, C, 1)
        b_off = (torch.arange(B) * S).reshape(B, 1)
        flat_idx = (idx + b_off).reshape(B * C)
        zero = (x * 0.0).reshape(B * S, D)
        upd = _scatter_add(zero, flat_idx, y.reshape(B * C, D), axis=0)
        return x + upd.reshape(B, S, D)

    x = A_x
    xn = _layernorm(x, axis=-1)
    s = _A_ref(xn, A_wq, A_wk, A_wv, A_wo)
    g = _silu(_B_ref(xn, B_w_r, B_w_gate, B_w_up, B_w_down))
    return x + s * g
```

```asm
; @launch grid=(256,1,1) block=(512,1,1) lds=163840
.amdgcn_target "amdgcn-amd-amdhsa--gfx950"
.text
.p2align 8
.globl recurrent_scan__grouped_kv_mqa__moe_arch_mod__prompt_kernel
.type recurrent_scan__grouped_kv_mqa__moe_arch_mod__prompt_kernel,@function
recurrent_scan__grouped_kv_mqa__moe_arch_mod__prompt_kernel:
    s_cmp_ge_u32 s2, 256
    s_cbranch_scc1 K2_END
    s_load_dwordx16 s[64:79], s[0:1], 0
    s_load_dwordx8 s[80:87], s[0:1], 64
    s_load_dwordx2 s[48:49], s[0:1], 96
    v_and_b32 v1, 63, v0
    v_lshrrev_b32 v6, 6, v0
    v_and_b32 v2, 31, v1
    v_lshrrev_b32 v3, 5, v1
    v_readfirstlane_b32 s60, v6
    v_lshlrev_b32 v4, 4, v1
    s_and_b32 s56, s2, 7
    s_lshr_b32 s57, s2, 3
    s_getpc_b64 s[52:53]
K_PC:
    s_and_b32 s58, s57, 3
    s_lshl_b32 s58, s58, 13
    s_add_u32 s58, s58, 1024
    v_lshl_add_u32 v6, v0, 4, s58
    v_min_u32 v6, K2_END-K_PC-16, v6
    global_load_dwordx4 v[252:255], v6, s[52:53]
    s_lshr_b32 s58, s57, 3
    s_lshl_b32 s61, s56, 2
    s_add_u32 s61, s61, s58
    s_and_b32 s62, s57, 7
    s_and_b32 s3, s60, 3
    s_and_b32 s18, s62, 1
    s_lshr_b32 s19, s60, 2
    s_mov_b32 s63, 0
    s_mov_b32 s59, 0
    v_and_b32 v5, 15, v2
    v_lshlrev_b32 v5, 4, v5
    v_lshl_add_u32 v5, v3, 8, v5
    v_add_u32 v5, 1024, v5
    s_waitcnt lgkmcnt(0)
    s_mov_b32 s20, s64
    s_and_b32 s21, s65, 0xffff
    s_mov_b32 s22, 0x200000
    s_mov_b32 s23, 0x00020000
    s_mov_b32 s4, s66
    s_and_b32 s5, s67, 0xffff
    s_mov_b32 s6, 0x80000
    s_mov_b32 s7, 0x00020000
    s_mov_b32 s24, s72
    s_and_b32 s25, s73, 0xffff
    s_mov_b32 s26, 0x80000
    s_mov_b32 s27, 0x00020000
    s_mov_b32 s8, s76
    s_and_b32 s9, s77, 0xffff
    s_mov_b32 s10, 0x400
    s_mov_b32 s11, 0x00020000
    s_mov_b32 s28, s78
    s_and_b32 s29, s79, 0xffff
    s_mov_b32 s30, 0x1c0000
    s_mov_b32 s31, 0x00020000
    s_mov_b32 s32, s80
    s_and_b32 s33, s81, 0xffff
    s_mov_b32 s34, 0x1c0000
    s_mov_b32 s35, 0x00020000
    s_mov_b32 s36, s82
    s_and_b32 s37, s83, 0xffff
    s_mov_b32 s38, 0x1c0000
    s_mov_b32 s39, 0x00020000
    s_mov_b32 s40, s84
    s_and_b32 s41, s85, 0xffff
    s_mov_b32 s42, 0x200000
    s_mov_b32 s43, 0x00020000
    s_mov_b32 s44, s48
    s_and_b32 s45, s49, 0xffff
    s_mov_b32 s46, 0x900000
    s_mov_b32 s47, 0x00020000
    s_mov_b32 s16, s86
    s_mov_b32 s17, s87
    s_cmp_lt_u32 s62, 2
    s_cselect_b32 s12, s68, s70
    s_cselect_b32 s13, s69, s71
    s_and_b32 s13, s13, 0xffff
    s_mov_b32 s14, 0x4000
    s_mov_b32 s15, 0x00020000
    s_lshl_b32 s64, s3, 15
    s_add_u32 s64, s64, 32768
    s_lshl_b32 s65, s3, 12
    s_add_u32 s65, s65, 8192
    s_cmp_lt_u32 s60, 4
    s_cbranch_scc1 P1_C
    s_add_u32 s67, s2, s3
    s_cmp_lg_u32 s67, 0
    s_cbranch_scc1 P1_NONCE0
    s_memrealtime s[70:71]
    v_mov_b32 v6, 0
    s_waitcnt lgkmcnt(0)
    s_or_b32 s70, s70, 1
    v_mov_b32 v7, s70
    s_mov_b64 exec, 1
    global_store_dword v6, v7, s[16:17] sc1
    s_mov_b64 exec, -1
P1_NONCE0:
    v_lshrrev_b32 v6, 4, v1
    v_and_b32 v7, 15, v1
    v_xor_b32 v7, v7, v6
    v_xor_b32 v8, 0, v7
    v_lshlrev_b32 v8, 4, v8
    v_lshl_add_u32 v8, v6, 10, v8
    v_xor_b32 v9, 4, v7
    v_lshlrev_b32 v9, 4, v9
    v_lshl_add_u32 v9, v6, 10, v9
    v_xor_b32 v10, 8, v7
    v_lshlrev_b32 v10, 4, v10
    v_lshl_add_u32 v10, v6, 10, v10
    v_xor_b32 v11, 12, v7
    v_lshlrev_b32 v11, 4, v11
    v_lshl_add_u32 v11, v6, 10, v11
    v_lshrrev_b32 v6, 3, v1
    v_and_b32 v12, 7, v1
    v_lshlrev_b32 v12, 4, v12
    v_lshl_add_u32 v12, v6, 10, v12
    s_lshl_b32 s66, s61, 16
    s_lshl_b32 s67, s3, 8
    s_add_u32 s66, s66, s67
    s_lshl_b32 s67, s18, 15
    s_add_u32 s72, s66, s67
    s_xor_b32 s67, s67, 32768
    s_add_u32 s73, s66, s67
    s_lshl_b32 s66, s3, 17
    s_lshl_b32 s67, s62, 7
    s_add_u32 s66, s66, s67
    s_cmp_ge_u32 s62, 4
    s_cbranch_scc1 P1_NOKVDMA
    s_lshl_b32 s67, s3, 12
    s_mov_b32 m0, s65
    s_nop 0
    buffer_load_dwordx4 v4, s[12:15], s67 offen offset:0 lds
    buffer_load_dwordx4 v4, s[12:15], s67 offen offset:1024 lds
    buffer_load_dwordx4 v4, s[12:15], s67 offen offset:2048 lds
    buffer_load_dwordx4 v4, s[12:15], s67 offen offset:3072 lds
P1_NOKVDMA:
    s_add_u32 m0, s64, 0
    s_add_u32 s67, s72, 0
    buffer_load_dwordx4 v8, s[20:23], s67 offen offset:0 lds
    s_add_u32 s67, s72, 3072
    buffer_load_dwordx4 v9, s[20:23], s67 offen offset:1024 lds
    s_add_u32 s67, s72, 6144
    buffer_load_dwordx4 v10, s[20:23], s67 offen offset:2048 lds
    s_add_u32 s67, s72, 9216
    buffer_load_dwordx4 v11, s[20:23], s67 offen offset:3072 lds
    s_add_u32 m0, s64, 4096
    s_add_u32 s67, s72, 16384
    buffer_load_dwordx4 v8, s[20:23], s67 offen offset:0 lds
    s_add_u32 s67, s72, 19456
    buffer_load_dwordx4 v9, s[20:23], s67 offen offset:1024 lds
    s_add_u32 s67, s72, 22528
    buffer_load_dwordx4 v10, s[20:23], s67 offen offset:2048 lds
    s_add_u32 s67, s72, 25600
    buffer_load_dwordx4 v11, s[20:23], s67 offen offset:3072 lds
    s_add_u32 m0, s64, 8192
    s_add_u32 s67, s73, 0
    buffer_load_dwordx4 v8, s[20:23], s67 offen offset:0 lds
    s_add_u32 s67, s73, 3072
    buffer_load_dwordx4 v9, s[20:23], s67 offen offset:1024 lds
    s_add_u32 s67, s73, 6144
    buffer_load_dwordx4 v10, s[20:23], s67 offen offset:2048 lds
    s_add_u32 s67, s73, 9216
    buffer_load_dwordx4 v11, s[20:23], s67 offen offset:3072 lds
    s_add_u32 m0, s64, 12288
    s_add_u32 s67, s73, 16384
    buffer_load_dwordx4 v8, s[20:23], s67 offen offset:0 lds
    s_add_u32 s67, s73, 19456
    buffer_load_dwordx4 v9, s[20:23], s67 offen offset:1024 lds
    s_add_u32 s67, s73, 22528
    buffer_load_dwordx4 v10, s[20:23], s67 offen offset:2048 lds
    s_add_u32 s67, s73, 25600
    buffer_load_dwordx4 v11, s[20:23], s67 offen offset:3072 lds
    v_mov_b32 v6, 0
    v_mov_b32 v7, 0
    v_mov_b32 v20, 2576
    ds_write_b64 v20, v[6:7]
    s_waitcnt vmcnt(8) lgkmcnt(0)
    s_barrier
    s_add_u32 m0, s64, 16384
    s_add_u32 s67, s66, 0
    buffer_load_dwordx4 v12, s[4:7], s67 offen offset:0 lds
    s_add_u32 s67, s66, 7168
    buffer_load_dwordx4 v12, s[4:7], s67 offen offset:1024 lds
    s_add_u32 s67, s66, 14336
    buffer_load_dwordx4 v12, s[4:7], s67 offen offset:2048 lds
    s_add_u32 s67, s66, 21504
    buffer_load_dwordx4 v12, s[4:7], s67 offen offset:3072 lds
    s_add_u32 m0, s64, 20480
    s_add_u32 s67, s66, 32768
    buffer_load_dwordx4 v12, s[4:7], s67 offen offset:0 lds
    s_add_u32 s67, s66, 39936
    buffer_load_dwordx4 v12, s[4:7], s67 offen offset:1024 lds
    s_add_u32 s67, s66, 47104
    buffer_load_dwordx4 v12, s[4:7], s67 offen offset:2048 lds
    s_add_u32 s67, s66, 54272
    buffer_load_dwordx4 v12, s[4:7], s67 offen offset:3072 lds
    s_add_u32 m0, s64, 24576
    s_add_u32 s67, s66, 65536
    buffer_load_dwordx4 v12, s[4:7], s67 offen offset:0 lds
    s_add_u32 s67, s66, 72704
    buffer_load_dwordx4 v12, s[4:7], s67 offen offset:1024 lds
    s_add_u32 s67, s66, 79872
    buffer_load_dwordx4 v12, s[4:7], s67 offen offset:2048 lds
    s_add_u32 s67, s66, 87040
    buffer_load_dwordx4 v12, s[4:7], s67 offen offset:3072 lds
    s_add_u32 m0, s64, 28672
    s_add_u32 s67, s66, 98304
    buffer_load_dwordx4 v12, s[4:7], s67 offen offset:0 lds
    s_add_u32 s67, s66, 105472
    buffer_load_dwordx4 v12, s[4:7], s67 offen offset:1024 lds
    s_add_u32 s67, s66, 112640
    buffer_load_dwordx4 v12, s[4:7], s67 offen offset:2048 lds
    s_add_u32 s67, s66, 119808
    buffer_load_dwordx4 v12, s[4:7], s67 offen offset:3072 lds
    v_mov_b32 v6, 0
    s_cmp_ge_u32 s3, 2
    s_cbranch_scc1 P1_L_NOTAG
    global_load_dword v7, v6, s[16:17] sc1
P1_L_NOTAG:
    s_barrier
    s_cmp_ge_u32 s62, 4
    s_cbranch_scc1 P1_L_B3
    s_cmp_lg_u32 s3, 1
    s_cbranch_scc1 P1_L_B3
    v_lshlrev_b32 v13, 2, v2
    ds_read_b32 v112, v13 offset:24576
    ds_read_b32 v116, v13 offset:24704
    ds_read_b32 v124, v13 offset:24832
    ds_read_b32 v113, v13 offset:25600
    ds_read_b32 v117, v13 offset:25728
    ds_read_b32 v125, v13 offset:25856
    ds_read_b32 v114, v13 offset:26624
    ds_read_b32 v118, v13 offset:26752
    ds_read_b32 v126, v13 offset:26880
    ds_read_b32 v115, v13 offset:27648
    ds_read_b32 v119, v13 offset:27776
    ds_read_b32 v127, v13 offset:27904
    s_waitcnt lgkmcnt(0)
    v_add_f32 v112, v112, v113
    v_add_f32 v114, v114, v115
    v_add_f32 v112, v112, v114
    v_add_f32 v116, v116, v117
    v_add_f32 v118, v118, v119
    v_add_f32 v116, v116, v118
    v_add_f32 v124, v124, v125
    v_add_f32 v126, v126, v127
    v_add_f32 v124, v124, v126
    v_mul_f32 v131, 0x3b000000, v112
    v_mul_f32 v132, 0x3b000000, v116
    v_cvt_pk_bf16_f32 v128, v131, v131
    v_and_b32 v128, 0xffff0000, v128
    v_fma_f32 v132, -v131, v131, v132
    v_max_f32 v132, 0, v132
    v_cvt_pk_bf16_f32 v132, v132, v132
    v_and_b32 v132, 0xffff0000, v132
    v_add_f32 v132, 0x3727c5ac, v132
    v_cvt_pk_bf16_f32 v132, v132, v132
    v_and_b32 v132, 0xffff0000, v132
    v_sqrt_f32 v132, v132
    s_nop 0
    v_cvt_pk_bf16_f32 v129, v132, v132
    v_and_b32 v129, 0xffff0000, v129
    v_rcp_f32 v130, v129
    s_nop 0
    ds_write_b32 v13, v128 offset:28672
    ds_write_b32 v13, v130 offset:28928
    ds_write_b32 v13, v124 offset:29312
    s_lshl_b32 s70, s61, 1
    s_add_u32 s70, s70, s18
    s_lshl_b32 s70, s70, 11
    s_add_u32 s70, s70, 0x200000
    v_lshlrev_b32 v11, 4, v3
    v_lshlrev_b32 v13, 2, v2
    s_cmp_lt_u32 s62, 2
    s_cbranch_scc1 P1_KV_K
    ds_read_b128 v[136:139], v4 offset:8192
    ds_read_b128 v[140:143], v4 offset:9216
    ds_read_b128 v[144:147], v4 offset:10240
    ds_read_b128 v[148:151], v4 offset:11264
    ds_read_b128 v[152:155], v4 offset:12288
    ds_read_b128 v[156:159], v4 offset:13312
    ds_read_b128 v[160:163], v4 offset:14336
    ds_read_b128 v[164:167], v4 offset:15360
    s_waitcnt lgkmcnt(6)
    ds_read_b128 v[168:171], v4 offset:16384
    ds_read_b128 v[172:175], v4 offset:17408
    ds_read_b128 v[176:179], v4 offset:18432
    ds_read_b128 v[180:183], v4 offset:19456
    s_waitcnt lgkmcnt(6)
    ds_read_b128 v[184:187], v4 offset:20480
    ds_read_b128 v[188:191], v4 offset:21504
    ds_read_b128 v[192:195], v4 offset:22528
    ds_read_b128 v[196:199], v4 offset:23552
    s_waitcnt lgkmcnt(6)
    ds_read_b128 v[200:203], v11 offset:28672
    ds_read_b128 v[216:219], v11 offset:28928
    ds_read_b128 v[204:207], v11 offset:28704
    ds_read_b128 v[220:223], v11 offset:28960
    ds_read_b128 v[208:211], v11 offset:28736
    ds_read_b128 v[224:227], v11 offset:28992
    ds_read_b128 v[212:215], v11 offset:28768
    ds_read_b128 v[228:231], v11 offset:29024
    ds_read_b32 v133, v13 offset:29312
    v_lshlrev_b32 v10, 4, v2
    v_lshl_add_u32 v10, v3, 8, v10
    s_waitcnt lgkmcnt(0)
    v_add_f32 v136, v136, v152
    v_add_f32 v168, v168, v184
    v_add_f32 v136, v136, v168
    v_fma_f32 v136, -v200, v133, v136
    v_mul_f32 v136, v216, v136
    v_add_f32 v137, v137, v153
    v_add_f32 v169, v169, v185
    v_add_f32 v137, v137, v169
    v_fma_f32 v137, -v201, v133, v137
    v_mul_f32 v137, v217, v137
    v_cvt_pk_bf16_f32 v232, v136, v137
    v_add_f32 v138, v138, v154
    v_add_f32 v170, v170, v186
    v_add_f32 v138, v138, v170
    v_fma_f32 v138, -v202, v133, v138
    v_mul_f32 v138, v218, v138
    v_add_f32 v139, v139, v155
    v_add_f32 v171, v171, v187
    v_add_f32 v139, v139, v171
    v_fma_f32 v139, -v203, v133, v139
    v_mul_f32 v139, v219, v139
    v_cvt_pk_bf16_f32 v233, v138, v139
    v_add_f32 v140, v140, v156
    v_add_f32 v172, v172, v188
    v_add_f32 v140, v140, v172
    v_fma_f32 v140, -v204, v133, v140
    v_mul_f32 v140, v220, v140
    v_add_f32 v141, v141, v157
    v_add_f32 v173, v173, v189
    v_add_f32 v141, v141, v173
    v_fma_f32 v141, -v205, v133, v141
    v_mul_f32 v141, v221, v141
    v_cvt_pk_bf16_f32 v234, v140, v141
    v_add_f32 v142, v142, v158
    v_add_f32 v174, v174, v190
    v_add_f32 v142, v142, v174
    v_fma_f32 v142, -v206, v133, v142
    v_mul_f32 v142, v222, v142
    v_add_f32 v143, v143, v159
    v_add_f32 v175, v175, v191
    v_add_f32 v143, v143, v175
    v_fma_f32 v143, -v207, v133, v143
    v_mul_f32 v143, v223, v143
    v_cvt_pk_bf16_f32 v235, v142, v143
    v_add_f32 v144, v144, v160
    v_add_f32 v176, v176, v192
    v_add_f32 v144, v144, v176
    v_fma_f32 v144, -v208, v133, v144
    v_mul_f32 v144, v224, v144
    v_add_f32 v145, v145, v161
    v_add_f32 v177, v177, v193
    v_add_f32 v145, v145, v177
    v_fma_f32 v145, -v209, v133, v145
    v_mul_f32 v145, v225, v145
    v_cvt_pk_bf16_f32 v236, v144, v145
    v_add_f32 v146, v146, v162
    v_add_f32 v178, v178, v194
    v_add_f32 v146, v146, v178
    v_fma_f32 v146, -v210, v133, v146
    v_mul_f32 v146, v226, v146
    v_add_f32 v147, v147, v163
    v_add_f32 v179, v179, v195
    v_add_f32 v147, v147, v179
    v_fma_f32 v147, -v211, v133, v147
    v_mul_f32 v147, v227, v147
    v_cvt_pk_bf16_f32 v237, v146, v147
    v_add_f32 v148, v148, v164
    v_add_f32 v180, v180, v196
    v_add_f32 v148, v148, v180
    v_fma_f32 v148, -v212, v133, v148
    v_mul_f32 v148, v228, v148
    v_add_f32 v149, v149, v165
    v_add_f32 v181, v181, v197
    v_add_f32 v149, v149, v181
    v_fma_f32 v149, -v213, v133, v149
    v_mul_f32 v149, v229, v149
    v_cvt_pk_bf16_f32 v238, v148, v149
    v_add_f32 v150, v150, v166
    v_add_f32 v182, v182, v198
    v_add_f32 v150, v150, v182
    v_fma_f32 v150, -v214, v133, v150
    v_mul_f32 v150, v230, v150
    v_add_f32 v151, v151, v167
    v_add_f32 v183, v183, v199
    v_add_f32 v151, v151, v183
    v_fma_f32 v151, -v215, v133, v151
    v_mul_f32 v151, v231, v151
    v_cvt_pk_bf16_f32 v239, v150, v151
    s_mov_b32 exec_lo, 0x0000ffff
    s_mov_b32 exec_hi, 0x0000ffff
    buffer_store_dwordx4 v[232:235], v10, s[44:47], s70 offen offset:1024 sc1
    buffer_store_dwordx4 v[236:239], v10, s[44:47], s70 offen offset:1536 sc1
    s_mov_b64 exec, -1
    s_branch P1_L_B3
P1_KV_K:
    ds_read_b128 v[136:139], v4 offset:8192
    ds_read_b128 v[140:143], v4 offset:9216
    ds_read_b128 v[144:147], v4 offset:12288
    ds_read_b128 v[148:151], v4 offset:13312
    ds_read_b128 v[152:155], v4 offset:16384
    ds_read_b128 v[156:159], v4 offset:17408
    ds_read_b128 v[160:163], v4 offset:20480
    ds_read_b128 v[164:167], v4 offset:21504
    ds_read_b128 v[200:203], v11 offset:29312
    ds_read_b128 v[204:207], v11 offset:29344
    ds_read_b32 v133, v13 offset:28672
    ds_read_b32 v134, v13 offset:28928
    s_waitcnt lgkmcnt(0)
    v_add_f32 v136, v136, v144
    v_add_f32 v152, v152, v160
    v_add_f32 v136, v136, v152
    v_fma_f32 v136, -v133, v200, v136
    v_mul_f32 v136, v134, v136
    v_add_f32 v137, v137, v145
    v_add_f32 v153, v153, v161
    v_add_f32 v137, v137, v153
    v_fma_f32 v137, -v133, v201, v137
    v_mul_f32 v137, v134, v137
    v_cvt_pk_bf16_f32 v232, v136, v137
    v_add_f32 v138, v138, v146
    v_add_f32 v154, v154, v162
    v_add_f32 v138, v138, v154
    v_fma_f32 v138, -v133, v202, v138
    v_mul_f32 v138, v134, v138
    v_add_f32 v139, v139, v147
    v_add_f32 v155, v155, v163
    v_add_f32 v139, v139, v155
    v_fma_f32 v139, -v133, v203, v139
    v_mul_f32 v139, v134, v139
    v_cvt_pk_bf16_f32 v233, v138, v139
    v_add_f32 v140, v140, v148
    v_add_f32 v156, v156, v164
    v_add_f32 v140, v140, v156
    v_fma_f32 v140, -v133, v204, v140
    v_mul_f32 v140, v134, v140
    v_add_f32 v141, v141, v149
    v_add_f32 v157, v157, v165
    v_add_f32 v141, v141, v157
    v_fma_f32 v141, -v133, v205, v141
    v_mul_f32 v141, v134, v141
    v_cvt_pk_bf16_f32 v234, v140, v141
    v_add_f32 v142, v142, v150
    v_add_f32 v158, v158, v166
    v_add_f32 v142, v142, v158
    v_fma_f32 v142, -v133, v206, v142
    v_mul_f32 v142, v134, v142
    v_add_f32 v143, v143, v151
    v_add_f32 v159, v159, v167
    v_add_f32 v143, v143, v159
    v_fma_f32 v143, -v133, v207, v143
    v_mul_f32 v143, v134, v143
    v_cvt_pk_bf16_f32 v235, v142, v143
    buffer_store_dwordx4 v[232:235], v4, s[44:47], s70 offen sc1
    s_branch P1_L_B3
    s_branch P1_L_B3
P1_L_B3:
    s_waitcnt vmcnt(2) lgkmcnt(0)
    s_cmp_ge_u32 s62, 4
    s_cbranch_scc1 P1_L_B3W
    s_cmp_lg_u32 s3, 1
    s_cbranch_scc1 P1_L_B3W
    s_cmp_ge_u32 s62, 2
    s_cbranch_scc1 P1_L_B3X
    s_waitcnt vmcnt(1)
    s_branch P1_L_B3X
P1_L_B3W:
    s_waitcnt vmcnt(0)
P1_L_B3X:
    s_barrier
    s_cmp_ge_u32 s62, 4
    s_cbranch_scc1 P1_C_NOFLAG
    s_cmp_lg_u32 s3, 1
    s_cbranch_scc1 P1_C_NOFLAG
    s_mov_b32 s76, 0x80000
    v_mov_b32 v6, 0
P1_C_SPINN:
    s_waitcnt vmcnt(0)
    v_readfirstlane_b32 s75, v7
    s_nop 3
    s_cmp_lg_u32 s75, 0
    s_cbranch_scc1 P1_C_GOTN
    s_sleep 16
    global_load_dword v7, v6, s[16:17] sc1
    s_sub_u32 s76, s76, 1
    s_cmp_lg_u32 s76, 0
    s_cbranch_scc1 P1_C_SPINN
P1_C_GOTN:
    v_lshlrev_b32 v6, 10, v1
    s_lshl_b32 s67, s2, 2
    s_add_u32 s67, s67, 0x2b0000
    s_mov_b32 exec_hi, 0
    buffer_store_dword v7, v6, s[44:47], s67 offen sc1
    s_mov_b64 exec, -1
P1_C_NOFLAG:
    v_mov_b32 v20, 2576
    s_mov_b32 s76, 0x80000
    s_cmp_lg_u32 s3, 0
    s_cbranch_scc1 P1_L_SPINL
P1_L_SPINN:
    s_waitcnt vmcnt(0)
    v_readfirstlane_b32 s75, v7
    s_nop 3
    s_cmp_lg_u32 s75, 0
    s_cbranch_scc1 P1_L_GOTN
    s_sleep 16
    global_load_dword v7, v6, s[16:17] sc1
    s_sub_u32 s76, s76, 1
    s_cmp_lg_u32 s76, 0
    s_cbranch_scc1 P1_L_SPINN
P1_L_GOTN:
    s_and_b32 s67, s2, 31
    s_lshl_b32 s67, s67, 10
    s_add_u32 s67, s67, 0x2b0000
P1_L_SPING:
    buffer_load_dwordx4 v[8:11], v4, s[44:47], s67 offen sc1
    s_waitcnt vmcnt(0)
    v_xor_b32 v8, v8, v7
    v_xor_b32 v9, v9, v7
    v_xor_b32 v10, v10, v7
    v_xor_b32 v11, v11, v7
    v_or3_b32 v8, v8, v9, v10
    v_or_b32 v8, v8, v11
    v_cmp_ne_u32 vcc, 0, v8
    s_and_b32 vcc_lo, vcc_lo, 0x00ff00ff
    s_and_b32 vcc_hi, vcc_hi, 0x00ff00ff
    s_cmp_eq_u64 vcc, 0
    s_cbranch_scc1 P1_L_GO
    s_sleep 8
    s_sub_u32 s76, s76, 1
    s_cmp_lg_u32 s76, 0
    s_cbranch_scc1 P1_L_SPING
P1_L_GO:
    ds_write_b32 v20, v7
    s_mov_b32 s67, s75
    s_branch P1_L_KV
P1_L_SPINL:
    ds_read_b32 v8, v20
    s_waitcnt lgkmcnt(0)
    v_readfirstlane_b32 s67, v8
    s_nop 3
    s_cmp_lg_u32 s67, 0
    s_cbranch_scc1 P1_L_KV
    s_sleep 1
    s_branch P1_L_SPINL
P1_L_KV:
    s_mov_b32 s80, s67
    s_lshl_b32 s75, s3, 15
    s_add_u32 s75, s75, 0x200000
    s_add_u32 m0, s64, 0
    s_add_u32 s67, s75, 0
    buffer_load_dwordx4 v4, s[44:47], s67 offen offset:0 sc1 lds
    buffer_load_dwordx4 v4, s[44:47], s67 offen offset:1024 sc1 lds
    buffer_load_dwordx4 v4, s[44:47], s67 offen offset:2048 sc1 lds
    buffer_load_dwordx4 v4, s[44:47], s67 offen offset:3072 sc1 lds
    s_add_u32 m0, s64, 4096
    s_add_u32 s67, s75, 4096
    buffer_load_dwordx4 v4, s[44:47], s67 offen offset:0 sc1 lds
    buffer_load_dwordx4 v4, s[44:47], s67 offen offset:1024 sc1 lds
    buffer_load_dwordx4 v4, s[44:47], s67 offen offset:2048 sc1 lds
    buffer_load_dwordx4 v4, s[44:47], s67 offen offset:3072 sc1 lds
    s_branch P1_B4
P1_C:
    v_mov_b32 v47, 0x3f803f80
    v_lshlrev_b32 v13, 4, v3
    s_lshl_b32 s67, s3, 8
    s_cmp_lg_u32 s62, 4
    s_cbranch_scc1 P1_NOWR
    buffer_load_dwordx4 v[200:203], v13, s[8:11], s67 offen offset:0
    buffer_load_dwordx4 v[204:207], v13, s[8:11], s67 offen offset:32
    buffer_load_dwordx4 v[208:211], v13, s[8:11], s67 offen offset:64
    buffer_load_dwordx4 v[212:215], v13, s[8:11], s67 offen offset:96
    buffer_load_dwordx4 v[216:219], v13, s[8:11], s67 offen offset:128
    buffer_load_dwordx4 v[220:223], v13, s[8:11], s67 offen offset:160
    buffer_load_dwordx4 v[224:227], v13, s[8:11], s67 offen offset:192
    buffer_load_dwordx4 v[228:231], v13, s[8:11], s67 offen offset:224
P1_NOWR:
    v_and_b32 v6, 15, v2
    v_xor_b32 v6, v6, v3
    v_lshlrev_b32 v7, 8, v2
    v_add_u32 v7, s64, v7
    v_xor_b32 v24, 0, v6
    v_lshl_add_u32 v24, v24, 4, v7
    v_xor_b32 v25, 2, v6
    v_lshl_add_u32 v25, v25, 4, v7
    v_xor_b32 v26, 4, v6
    v_lshl_add_u32 v26, v26, 4, v7
    v_xor_b32 v27, 6, v6
    v_lshl_add_u32 v27, v27, 4, v7
    v_xor_b32 v28, 8, v6
    v_lshl_add_u32 v28, v28, 4, v7
    v_xor_b32 v29, 10, v6
    v_lshl_add_u32 v29, v29, 4, v7
    v_xor_b32 v30, 12, v6
    v_lshl_add_u32 v30, v30, 4, v7
    v_xor_b32 v31, 14, v6
    v_lshl_add_u32 v31, v31, 4, v7
    v_bfe_u32 v6, v1, 2, 2
    v_lshl_add_u32 v6, v3, 3, v6
    v_and_b32 v7, 1, v1
    v_bfe_u32 v15, v1, 1, 1
    v_lshl_add_u32 v7, v7, 1, v15
    v_bfe_u32 v15, v1, 4, 1
    v_lshlrev_b32 v20, 7, v6
    v_lshl_add_u32 v20, v15, 5, v20
    v_lshl_add_u32 v20, v7, 3, v20
    v_add_u32 v20, s64, v20
    v_lshlrev_b32 v6, 5, v6
    v_add_u32 v6, s65, v6
    v_lshl_add_u32 v21, v7, 3, v6
    v_and_b32 v22, 3, v1
    v_lshl_add_u32 v22, v22, 3, v6
    s_cmp_lt_u32 s62, 2
    s_cbranch_scc1 P1_KADDR
    v_mov_b32 v21, v22
P1_KADDR:
    v_mov_b32 v32, 0
    v_mov_b32 v33, 0
    v_mov_b32 v34, 0
    v_mov_b32 v35, 0
    v_mov_b32 v36, 0
    v_mov_b32 v37, 0
    v_mov_b32 v38, 0
    v_mov_b32 v39, 0
    v_mov_b32 v40, 0
    v_mov_b32 v41, 0
    v_mov_b32 v42, 0
    v_mov_b32 v43, 0
    v_mov_b32 v44, 0
    v_mov_b32 v45, 0
    s_waitcnt vmcnt(0)
    s_barrier
    ds_read_b128 v[48:51], v24
    ds_read_b128 v[56:59], v25
    ds_read_b128 v[64:67], v26
    ds_read_b128 v[72:75], v27
    ds_read_b128 v[80:83], v28
    ds_read_b128 v[88:91], v29
    ds_read_b128 v[96:99], v30
    ds_read_b128 v[104:107], v31
    s_cmp_ge_u32 s62, 4
    s_cbranch_scc1 P1_NOKF
    s_waitcnt lgkmcnt(12)
    ds_read_b64_tr_b16 v[200:201], v21 offset:0
    ds_read_b64_tr_b16 v[202:203], v21 offset:128
    s_waitcnt lgkmcnt(12)
    ds_read_b64_tr_b16 v[204:205], v21 offset:512
    ds_read_b64_tr_b16 v[206:207], v21 offset:640
    s_waitcnt lgkmcnt(12)
    ds_read_b64_tr_b16 v[208:209], v21 offset:1024
    ds_read_b64_tr_b16 v[210:211], v21 offset:1152
    s_waitcnt lgkmcnt(12)
    ds_read_b64_tr_b16 v[212:213], v21 offset:1536
    ds_read_b64_tr_b16 v[214:215], v21 offset:1664
    s_waitcnt lgkmcnt(12)
    ds_read_b64_tr_b16 v[216:217], v21 offset:2048
    ds_read_b64_tr_b16 v[218:219], v21 offset:2176
    s_waitcnt lgkmcnt(12)
    ds_read_b64_tr_b16 v[220:221], v21 offset:2560
    ds_read_b64_tr_b16 v[222:223], v21 offset:2688
    s_waitcnt lgkmcnt(12)
    ds_read_b64_tr_b16 v[224:225], v21 offset:3072
    ds_read_b64_tr_b16 v[226:227], v21 offset:3200
    s_waitcnt lgkmcnt(12)
    ds_read_b64_tr_b16 v[228:229], v21 offset:3584
    ds_read_b64_tr_b16 v[230:231], v21 offset:3712
P1_NOKF:
    s_waitcnt lgkmcnt(0)
    v_dot2_f32_bf16 v32, v48, v47, v32
    v_dot2_f32_bf16 v34, v48, v48, v34
    v_dot2_f32_bf16 v42, v49, v47, v42
    v_dot2_f32_bf16 v44, v49, v49, v44
    v_dot2_f32_bf16 v32, v50, v47, v32
    v_dot2_f32_bf16 v34, v50, v50, v34
    v_dot2_f32_bf16 v42, v51, v47, v42
    v_dot2_f32_bf16 v44, v51, v51, v44
    v_dot2_f32_bf16 v32, v56, v47, v32
    v_dot2_f32_bf16 v34, v56, v56, v34
    v_dot2_f32_bf16 v42, v57, v47, v42
    v_dot2_f32_bf16 v44, v57, v57, v44
    v_dot2_f32_bf16 v32, v58, v47, v32
    v_dot2_f32_bf16 v34, v58, v58, v34
    v_dot2_f32_bf16 v42, v59, v47, v42
    v_dot2_f32_bf16 v44, v59, v59, v44
    v_dot2_f32_bf16 v32, v64, v47, v32
    v_dot2_f32_bf16 v34, v64, v64, v34
    v_dot2_f32_bf16 v42, v65, v47, v42
    v_dot2_f32_bf16 v44, v65, v65, v44
    v_dot2_f32_bf16 v32, v66, v47, v32
    v_dot2_f32_bf16 v34, v66, v66, v34
    v_dot2_f32_bf16 v42, v67, v47, v42
    v_dot2_f32_bf16 v44, v67, v67, v44
    v_dot2_f32_bf16 v32, v72, v47, v32
    v_dot2_f32_bf16 v34, v72, v72, v34
    v_dot2_f32_bf16 v42, v73, v47, v42
    v_dot2_f32_bf16 v44, v73, v73, v44
    v_dot2_f32_bf16 v32, v74, v47, v32
    v_dot2_f32_bf16 v34, v74, v74, v34
    v_dot2_f32_bf16 v42, v75, v47, v42
    v_dot2_f32_bf16 v44, v75, v75, v44
    v_dot2_f32_bf16 v32, v80, v47, v32
    v_dot2_f32_bf16 v34, v80, v80, v34
    v_dot2_f32_bf16 v42, v81, v47, v42
    v_dot2_f32_bf16 v44, v81, v81, v44
    v_dot2_f32_bf16 v32, v82, v47, v32
    v_dot2_f32_bf16 v34, v82, v82, v34
    v_dot2_f32_bf16 v42, v83, v47, v42
    v_dot2_f32_bf16 v44, v83, v83, v44
    v_dot2_f32_bf16 v32, v88, v47, v32
    v_dot2_f32_bf16 v34, v88, v88, v34
    v_dot2_f32_bf16 v42, v89, v47, v42
    v_dot2_f32_bf16 v44, v89, v89, v44
    v_dot2_f32_bf16 v32, v90, v47, v32
    v_dot2_f32_bf16 v34, v90, v90, v34
    v_dot2_f32_bf16 v42, v91, v47, v42
    v_dot2_f32_bf16 v44, v91, v91, v44
    v_dot2_f32_bf16 v32, v96, v47, v32
    v_dot2_f32_bf16 v34, v96, v96, v34
    v_dot2_f32_bf16 v42, v97, v47, v42
    v_dot2_f32_bf16 v44, v97, v97, v44
    v_dot2_f32_bf16 v32, v98, v47, v32
    v_dot2_f32_bf16 v34, v98, v98, v34
    v_dot2_f32_bf16 v42, v99, v47, v42
    v_dot2_f32_bf16 v44, v99, v99, v44
    v_dot2_f32_bf16 v32, v104, v47, v32
    v_dot2_f32_bf16 v34, v104, v104, v34
    v_dot2_f32_bf16 v42, v105, v47, v42
    v_dot2_f32_bf16 v44, v105, v105, v44
    v_dot2_f32_bf16 v32, v106, v47, v32
    v_dot2_f32_bf16 v34, v106, v106, v34
    v_dot2_f32_bf16 v42, v107, v47, v42
    v_dot2_f32_bf16 v44, v107, v107, v44
    s_cmp_ge_u32 s62, 4
    s_cbranch_scc1 P1_C_B2
    v_dot2_f32_bf16 v40, v200, v47, v40
    v_dot2_f32_bf16 v41, v201, v47, v41
    v_dot2_f32_bf16 v40, v202, v47, v40
    v_dot2_f32_bf16 v41, v203, v47, v41
    v_dot2_f32_bf16 v40, v204, v47, v40
    v_dot2_f32_bf16 v41, v205, v47, v41
    v_dot2_f32_bf16 v40, v206, v47, v40
    v_dot2_f32_bf16 v41, v207, v47, v41
    v_dot2_f32_bf16 v40, v208, v47, v40
    v_dot2_f32_bf16 v41, v209, v47, v41
    v_dot2_f32_bf16 v40, v210, v47, v40
    v_dot2_f32_bf16 v41, v211, v47, v41
    v_dot2_f32_bf16 v40, v212, v47, v40
    v_dot2_f32_bf16 v41, v213, v47, v41
    v_dot2_f32_bf16 v40, v214, v47, v40
    v_dot2_f32_bf16 v41, v215, v47, v41
    v_dot2_f32_bf16 v40, v216, v47, v40
    v_dot2_f32_bf16 v41, v217, v47, v41
    v_dot2_f32_bf16 v40, v218, v47, v40
    v_dot2_f32_bf16 v41, v219, v47, v41
    v_dot2_f32_bf16 v40, v220, v47, v40
    v_dot2_f32_bf16 v41, v221, v47, v41
    v_dot2_f32_bf16 v40, v222, v47, v40
    v_dot2_f32_bf16 v41, v223, v47, v41
    v_dot2_f32_bf16 v40, v224, v47, v40
    v_dot2_f32_bf16 v41, v225, v47, v41
    v_dot2_f32_bf16 v40, v226, v47, v40
    v_dot2_f32_bf16 v41, v227, v47, v41
    v_dot2_f32_bf16 v40, v228, v47, v40
    v_dot2_f32_bf16 v41, v229, v47, v41
    v_dot2_f32_bf16 v40, v230, v47, v40
    v_dot2_f32_bf16 v41, v231, v47, v41
    s_cmp_lt_u32 s62, 2
    s_cbranch_scc1 P1_XK
    v_mfma_f32_32x32x16_bf16 v[232:247], v[48:51], v[200:203], 0
    v_mfma_f32_32x32x16_bf16 v[232:247], v[56:59], v[204:207], v[232:247]
    v_mfma_f32_32x32x16_bf16 v[232:247], v[64:67], v[208:211], v[232:247]
    v_mfma_f32_32x32x16_bf16 v[232:247], v[72:75], v[212:215], v[232:247]
    v_mfma_f32_32x32x16_bf16 v[232:247], v[80:83], v[216:219], v[232:247]
    v_mfma_f32_32x32x16_bf16 v[232:247], v[88:91], v[220:223], v[232:247]
    v_mfma_f32_32x32x16_bf16 v[232:247], v[96:99], v[224:227], v[232:247]
    v_mfma_f32_32x32x16_bf16 v[232:247], v[104:107], v[228:231], v[232:247]
    s_branch P1_XDONE
P1_XK:
    v_mfma_f32_32x32x16_bf16 v[232:247], v[200:203], v[48:51], 0
    v_mfma_f32_32x32x16_bf16 v[232:247], v[204:207], v[56:59], v[232:247]
    v_mfma_f32_32x32x16_bf16 v[232:247], v[208:211], v[64:67], v[232:247]
    v_mfma_f32_32x32x16_bf16 v[232:247], v[212:215], v[72:75], v[232:247]
    v_mfma_f32_32x32x16_bf16 v[232:247], v[216:219], v[80:83], v[232:247]
    v_mfma_f32_32x32x16_bf16 v[232:247], v[220:223], v[88:91], v[232:247]
    v_mfma_f32_32x32x16_bf16 v[232:247], v[224:227], v[96:99], v[232:247]
    v_mfma_f32_32x32x16_bf16 v[232:247], v[228:231], v[104:107], v[232:247]
P1_XDONE:
    v_add_f32 v112, v32, v42
    v_add_f32 v113, v34, v44
    v_add_f32 v114, v41, v40
    v_mov_b32 v115, v114
    s_nop 1
    v_permlane32_swap_b32 v112, v113
    s_nop 1
    v_add_f32 v112, v112, v113
    s_nop 1
    v_permlane32_swap_b32 v114, v115
    s_nop 1
    v_add_f32 v114, v114, v115
    s_lshl_b32 s67, s3, 10
    v_lshl_add_u32 v6, v1, 2, s67
    ds_write_b32 v6, v112 offset:24576
    ds_write_b32 v6, v114 offset:24832
    v_add_u32 v7, s65, v4
    ds_write_b128 v7, v[232:235] offset:0
    ds_write_b128 v7, v[236:239] offset:1024
    ds_write_b128 v7, v[240:243] offset:2048
    ds_write_b128 v7, v[244:247] offset:3072
    s_waitcnt lgkmcnt(0)
P1_C_B2:
    s_barrier
P1_C_B3:
    s_waitcnt lgkmcnt(0)
    s_barrier
    ds_read_b128 v[52:55], v24 offset:8192
    ds_read_b128 v[60:63], v25 offset:8192
    ds_read_b128 v[68:71], v26 offset:8192
    ds_read_b128 v[76:79], v27 offset:8192
    ds_read_b128 v[84:87], v28 offset:8192
    ds_read_b128 v[92:95], v29 offset:8192
    ds_read_b128 v[100:103], v30 offset:8192
    ds_read_b128 v[108:111], v31 offset:8192
    v_add_f32 v32, v32, v42
    v_add_f32 v34, v34, v44
    v_mov_b32 v40, 0
    v_mov_b32 v42, 0
    v_mov_b32 v44, 0
    s_waitcnt lgkmcnt(0)
    v_dot2_f32_bf16 v33, v52, v47, v33
    v_dot2_f32_bf16 v35, v52, v52, v35
    v_dot2_f32_bf16 v42, v53, v47, v42
    v_dot2_f32_bf16 v44, v53, v53, v44
    v_dot2_f32_bf16 v33, v54, v47, v33
    v_dot2_f32_bf16 v35, v54, v54, v35
    v_dot2_f32_bf16 v42, v55, v47, v42
    v_dot2_f32_bf16 v44, v55, v55, v44
    v_dot2_f32_bf16 v33, v60, v47, v33
    v_dot2_f32_bf16 v35, v60, v60, v35
    v_dot2_f32_bf16 v42, v61, v47, v42
    v_dot2_f32_bf16 v44, v61, v61, v44
    v_dot2_f32_bf16 v33, v62, v47, v33
    v_dot2_f32_bf16 v35, v62, v62, v35
    v_dot2_f32_bf16 v42, v63, v47, v42
    v_dot2_f32_bf16 v44, v63, v63, v44
    v_dot2_f32_bf16 v33, v68, v47, v33
    v_dot2_f32_bf16 v35, v68, v68, v35
    v_dot2_f32_bf16 v42, v69, v47, v42
    v_dot2_f32_bf16 v44, v69, v69, v44
    v_dot2_f32_bf16 v33, v70, v47, v33
    v_dot2_f32_bf16 v35, v70, v70, v35
    v_dot2_f32_bf16 v42, v71, v47, v42
    v_dot2_f32_bf16 v44, v71, v71, v44
    v_dot2_f32_bf16 v33, v76, v47, v33
    v_dot2_f32_bf16 v35, v76, v76, v35
    v_dot2_f32_bf16 v42, v77, v47, v42
    v_dot2_f32_bf16 v44, v77, v77, v44
    v_dot2_f32_bf16 v33, v78, v47, v33
    v_dot2_f32_bf16 v35, v78, v78, v35
    v_dot2_f32_bf16 v42, v79, v47, v42
    v_dot2_f32_bf16 v44, v79, v79, v44
    v_dot2_f32_bf16 v33, v84, v47, v33
    v_dot2_f32_bf16 v35, v84, v84, v35
    v_dot2_f32_bf16 v42, v85, v47, v42
    v_dot2_f32_bf16 v44, v85, v85, v44
    v_dot2_f32_bf16 v33, v86, v47, v33
    v_dot2_f32_bf16 v35, v86, v86, v35
    v_dot2_f32_bf16 v42, v87, v47, v42
    v_dot2_f32_bf16 v44, v87, v87, v44
    v_dot2_f32_bf16 v33, v92, v47, v33
    v_dot2_f32_bf16 v35, v92, v92, v35
    v_dot2_f32_bf16 v42, v93, v47, v42
    v_dot2_f32_bf16 v44, v93, v93, v44
    v_dot2_f32_bf16 v33, v94, v47, v33
    v_dot2_f32_bf16 v35, v94, v94, v35
    v_dot2_f32_bf16 v42, v95, v47, v42
    v_dot2_f32_bf16 v44, v95, v95, v44
    v_dot2_f32_bf16 v33, v100, v47, v33
    v_dot2_f32_bf16 v35, v100, v100, v35
    v_dot2_f32_bf16 v42, v101, v47, v42
    v_dot2_f32_bf16 v44, v101, v101, v44
    v_dot2_f32_bf16 v33, v102, v47, v33
    v_dot2_f32_bf16 v35, v102, v102, v35
    v_dot2_f32_bf16 v42, v103, v47, v42
    v_dot2_f32_bf16 v44, v103, v103, v44
    v_dot2_f32_bf16 v33, v108, v47, v33
    v_dot2_f32_bf16 v35, v108, v108, v35
    v_dot2_f32_bf16 v42, v109, v47, v42
    v_dot2_f32_bf16 v44, v109, v109, v44
    v_dot2_f32_bf16 v33, v110, v47, v33
    v_dot2_f32_bf16 v35, v110, v110, v35
    v_dot2_f32_bf16 v42, v111, v47, v42
    v_dot2_f32_bf16 v44, v111, v111, v44
    s_cmp_lg_u32 s62, 4
    s_cbranch_scc1 P1_NOXR
    v_dot2_f32_bf16 v38, v48, v200, v38
    v_dot2_f32_bf16 v39, v52, v200, v39
    v_dot2_f32_bf16 v40, v200, v47, v40
    v_dot2_f32_bf16 v38, v49, v201, v38
    v_dot2_f32_bf16 v39, v53, v201, v39
    v_dot2_f32_bf16 v40, v201, v47, v40
    v_dot2_f32_bf16 v38, v50, v202, v38
    v_dot2_f32_bf16 v39, v54, v202, v39
    v_dot2_f32_bf16 v40, v202, v47, v40
    v_dot2_f32_bf16 v38, v51, v203, v38
    v_dot2_f32_bf16 v39, v55, v203, v39
    v_dot2_f32_bf16 v40, v203, v47, v40
    v_dot2_f32_bf16 v38, v56, v204, v38
    v_dot2_f32_bf16 v39, v60, v204, v39
    v_dot2_f32_bf16 v40, v204, v47, v40
    v_dot2_f32_bf16 v38, v57, v205, v38
    v_dot2_f32_bf16 v39, v61, v205, v39
    v_dot2_f32_bf16 v40, v205, v47, v40
    v_dot2_f32_bf16 v38, v58, v206, v38
    v_dot2_f32_bf16 v39, v62, v206, v39
    v_dot2_f32_bf16 v40, v206, v47, v40
    v_dot2_f32_bf16 v38, v59, v207, v38
    v_dot2_f32_bf16 v39, v63, v207, v39
    v_dot2_f32_bf16 v40, v207, v47, v40
    v_dot2_f32_bf16 v38, v64, v208, v38
    v_dot2_f32_bf16 v39, v68, v208, v39
    v_dot2_f32_bf16 v40, v208, v47, v40
    v_dot2_f32_bf16 v38, v65, v209, v38
    v_dot2_f32_bf16 v39, v69, v209, v39
    v_dot2_f32_bf16 v40, v209, v47, v40
    v_dot2_f32_bf16 v38, v66, v210, v38
    v_dot2_f32_bf16 v39, v70, v210, v39
    v_dot2_f32_bf16 v40, v210, v47, v40
    v_dot2_f32_bf16 v38, v67, v211, v38
    v_dot2_f32_bf16 v39, v71, v211, v39
    v_dot2_f32_bf16 v40, v211, v47, v40
    v_dot2_f32_bf16 v38, v72, v212, v38
    v_dot2_f32_bf16 v39, v76, v212, v39
    v_dot2_f32_bf16 v40, v212, v47, v40
    v_dot2_f32_bf16 v38, v73, v213, v38
    v_dot2_f32_bf16 v39, v77, v213, v39
    v_dot2_f32_bf16 v40, v213, v47, v40
    v_dot2_f32_bf16 v38, v74, v214, v38
    v_dot2_f32_bf16 v39, v78, v214, v39
    v_dot2_f32_bf16 v40, v214, v47, v40
    v_dot2_f32_bf16 v38, v75, v215, v38
    v_dot2_f32_bf16 v39, v79, v215, v39
    v_dot2_f32_bf16 v40, v215, v47, v40
    v_dot2_f32_bf16 v38, v80, v216, v38
    v_dot2_f32_bf16 v39, v84, v216, v39
    v_dot2_f32_bf16 v40, v216, v47, v40
    v_dot2_f32_bf16 v38, v81, v217, v38
    v_dot2_f32_bf16 v39, v85, v217, v39
    v_dot2_f32_bf16 v40, v217, v47, v40
    v_dot2_f32_bf16 v38, v82, v218, v38
    v_dot2_f32_bf16 v39, v86, v218, v39
    v_dot2_f32_bf16 v40, v218, v47, v40
    v_dot2_f32_bf16 v38, v83, v219, v38
    v_dot2_f32_bf16 v39, v87, v219, v39
    v_dot2_f32_bf16 v40, v219, v47, v40
    v_dot2_f32_bf16 v38, v88, v220, v38
    v_dot2_f32_bf16 v39, v92, v220, v39
    v_dot2_f32_bf16 v40, v220, v47, v40
    v_dot2_f32_bf16 v38, v89, v221, v38
    v_dot2_f32_bf16 v39, v93, v221, v39
    v_dot2_f32_bf16 v40, v221, v47, v40
    v_dot2_f32_bf16 v38, v90, v222, v38
    v_dot2_f32_bf16 v39, v94, v222, v39
    v_dot2_f32_bf16 v40, v222, v47, v40
    v_dot2_f32_bf16 v38, v91, v223, v38
    v_dot2_f32_bf16 v39, v95, v223, v39
    v_dot2_f32_bf16 v40, v223, v47, v40
    v_dot2_f32_bf16 v38, v96, v224, v38
    v_dot2_f32_bf16 v39, v100, v224, v39
    v_dot2_f32_bf16 v40, v224, v47, v40
    v_dot2_f32_bf16 v38, v97, v225, v38
    v_dot2_f32_bf16 v39, v101, v225, v39
    v_dot2_f32_bf16 v40, v225, v47, v40
    v_dot2_f32_bf16 v38, v98, v226, v38
    v_dot2_f32_bf16 v39, v102, v226, v39
    v_dot2_f32_bf16 v40, v226, v47, v40
    v_dot2_f32_bf16 v38, v99, v227, v38
    v_dot2_f32_bf16 v39, v103, v227, v39
    v_dot2_f32_bf16 v40, v227, v47, v40
    v_dot2_f32_bf16 v38, v104, v228, v38
    v_dot2_f32_bf16 v39, v108, v228, v39
    v_dot2_f32_bf16 v40, v228, v47, v40
    v_dot2_f32_bf16 v38, v105, v229, v38
    v_dot2_f32_bf16 v39, v109, v229, v39
    v_dot2_f32_bf16 v40, v229, v47, v40
    v_dot2_f32_bf16 v38, v106, v230, v38
    v_dot2_f32_bf16 v39, v110, v230, v39
    v_dot2_f32_bf16 v40, v230, v47, v40
    v_dot2_f32_bf16 v38, v107, v231, v38
    v_dot2_f32_bf16 v39, v111, v231, v39
    v_dot2_f32_bf16 v40, v231, v47, v40
P1_NOXR:
    ds_read_b64_tr_b16 v[176:177], v20 offset:16384
    ds_read_b64_tr_b16 v[178:179], v20 offset:16896
    ds_read_b64_tr_b16 v[180:181], v20 offset:16448
    ds_read_b64_tr_b16 v[182:183], v20 offset:16960
    ds_read_b64_tr_b16 v[184:185], v20 offset:18432
    ds_read_b64_tr_b16 v[186:187], v20 offset:18944
    ds_read_b64_tr_b16 v[188:189], v20 offset:18496
    ds_read_b64_tr_b16 v[190:191], v20 offset:19008
    ds_read_b64_tr_b16 v[192:193], v20 offset:20480
    ds_read_b64_tr_b16 v[194:195], v20 offset:20992
    ds_read_b64_tr_b16 v[196:197], v20 offset:20544
    ds_read_b64_tr_b16 v[198:199], v20 offset:21056
    s_waitcnt lgkmcnt(8)
    v_dot2_f32_bf16 v36, v176, v47, v36
    v_dot2_f32_bf16 v37, v180, v47, v37
    v_dot2_f32_bf16 v36, v177, v47, v36
    v_dot2_f32_bf16 v37, v181, v47, v37
    v_dot2_f32_bf16 v36, v178, v47, v36
    v_dot2_f32_bf16 v37, v182, v47, v37
    v_dot2_f32_bf16 v36, v179, v47, v36
    v_dot2_f32_bf16 v37, v183, v47, v37
    ds_read_b64_tr_b16 v[200:201], v20 offset:22528
    ds_read_b64_tr_b16 v[202:203], v20 offset:23040
    ds_read_b64_tr_b16 v[204:205], v20 offset:22592
    ds_read_b64_tr_b16 v[206:207], v20 offset:23104
    s_waitcnt lgkmcnt(8)
    v_dot2_f32_bf16 v36, v184, v47, v36
    v_dot2_f32_bf16 v37, v188, v47, v37
    v_dot2_f32_bf16 v36, v185, v47, v36
    v_dot2_f32_bf16 v37, v189, v47, v37
    v_dot2_f32_bf16 v36, v186, v47, v36
    v_dot2_f32_bf16 v37, v190, v47, v37
    v_dot2_f32_bf16 v36, v187, v47, v36
    v_dot2_f32_bf16 v37, v191, v47, v37
    ds_read_b64_tr_b16 v[208:209], v20 offset:24576
    ds_read_b64_tr_b16 v[210:211], v20 offset:25088
    ds_read_b64_tr_b16 v[212:213], v20 offset:24640
    ds_read_b64_tr_b16 v[214:215], v20 offset:25152
    s_waitcnt lgkmcnt(8)
    v_dot2_f32_bf16 v36, v192, v47, v36
    v_dot2_f32_bf16 v37, v196, v47, v37
    v_dot2_f32_bf16 v36, v193, v47, v36
    v_dot2_f32_bf16 v37, v197, v47, v37
    v_dot2_f32_bf16 v36, v194, v47, v36
    v_dot2_f32_bf16 v37, v198, v47, v37
    v_dot2_f32_bf16 v36, v195, v47, v36
    v_dot2_f32_bf16 v37, v199, v47, v37
    ds_read_b64_tr_b16 v[216:217], v20 offset:26624
    ds_read_b64_tr_b16 v[218:219], v20 offset:27136
    ds_read_b64_tr_b16 v[220:221], v20 offset:26688
    ds_read_b64_tr_b16 v[222:223], v20 offset:27200
    s_waitcnt lgkmcnt(8)
    v_dot2_f32_bf16 v36, v200, v47, v36
    v_dot2_f32_bf16 v37, v204, v47, v37
    v_dot2_f32_bf16 v36, v201, v47, v36
    v_dot2_f32_bf16 v37, v205, v47, v37
    v_dot2_f32_bf16 v36, v202, v47, v36
    v_dot2_f32_bf16 v37, v206, v47, v37
    v_dot2_f32_bf16 v36, v203, v47, v36
    v_dot2_f32_bf16 v37, v207, v47, v37
    ds_read_b64_tr_b16 v[224:225], v20 offset:28672
    ds_read_b64_tr_b16 v[226:227], v20 offset:29184
    ds_read_b64_tr_b16 v[228:229], v20 offset:28736
    ds_read_b64_tr_b16 v[230:231], v20 offset:29248
    s_waitcnt lgkmcnt(8)
    v_dot2_f32_bf16 v36, v208, v47, v36
    v_dot2_f32_bf16 v37, v212, v47, v37
    v_dot2_f32_bf16 v36, v209, v47, v36
    v_dot2_f32_bf16 v37, v213, v47, v37
    v_dot2_f32_bf16 v36, v210, v47, v36
    v_dot2_f32_bf16 v37, v214, v47, v37
    v_dot2_f32_bf16 v36, v211, v47, v36
    v_dot2_f32_bf16 v37, v215, v47, v37
    ds_read_b64_tr_b16 v[232:233], v20 offset:30720
    ds_read_b64_tr_b16 v[234:235], v20 offset:31232
    ds_read_b64_tr_b16 v[236:237], v20 offset:30784
    ds_read_b64_tr_b16 v[238:239], v20 offset:31296
    s_waitcnt lgkmcnt(8)
    v_dot2_f32_bf16 v36, v216, v47, v36
    v_dot2_f32_bf16 v37, v220, v47, v37
    v_dot2_f32_bf16 v36, v217, v47, v36
    v_dot2_f32_bf16 v37, v221, v47, v37
    v_dot2_f32_bf16 v36, v218, v47, v36
    v_dot2_f32_bf16 v37, v222, v47, v37
    v_dot2_f32_bf16 v36, v219, v47, v36
    v_dot2_f32_bf16 v37, v223, v47, v37
    s_waitcnt lgkmcnt(0)
    v_dot2_f32_bf16 v36, v224, v47, v36
    v_dot2_f32_bf16 v37, v228, v47, v37
    v_dot2_f32_bf16 v36, v225, v47, v36
    v_dot2_f32_bf16 v37, v229, v47, v37
    v_dot2_f32_bf16 v36, v226, v47, v36
    v_dot2_f32_bf16 v37, v230, v47, v37
    v_dot2_f32_bf16 v36, v227, v47, v36
    v_dot2_f32_bf16 v37, v231, v47, v37
    v_dot2_f32_bf16 v36, v232, v47, v36
    v_dot2_f32_bf16 v37, v236, v47, v37
    v_dot2_f32_bf16 v36, v233, v47, v36
    v_dot2_f32_bf16 v37, v237, v47, v37
    v_dot2_f32_bf16 v36, v234, v47, v36
    v_dot2_f32_bf16 v37, v238, v47, v37
    v_dot2_f32_bf16 v36, v235, v47, v36
    v_dot2_f32_bf16 v37, v239, v47, v37
    v_mfma_f32_32x32x16_bf16 v[112:127], v[176:179], v[48:51], 0
    v_mfma_f32_32x32x16_bf16 v[128:143], v[180:183], v[48:51], 0
    v_mfma_f32_32x32x16_bf16 v[144:159], v[176:179], v[52:55], 0
    v_mfma_f32_32x32x16_bf16 v[160:175], v[180:183], v[52:55], 0
    v_mfma_f32_32x32x16_bf16 v[112:127], v[184:187], v[56:59], v[112:127]
    v_mfma_f32_32x32x16_bf16 v[128:143], v[188:191], v[56:59], v[128:143]
    v_mfma_f32_32x32x16_bf16 v[144:159], v[184:187], v[60:63], v[144:159]
    v_mfma_f32_32x32x16_bf16 v[160:175], v[188:191], v[60:63], v[160:175]
    v_mfma_f32_32x32x16_bf16 v[112:127], v[192:195], v[64:67], v[112:127]
    v_mfma_f32_32x32x16_bf16 v[128:143], v[196:199], v[64:67], v[128:143]
    v_mfma_f32_32x32x16_bf16 v[144:159], v[192:195], v[68:71], v[144:159]
    v_mfma_f32_32x32x16_bf16 v[160:175], v[196:199], v[68:71], v[160:175]
    v_mfma_f32_32x32x16_bf16 v[112:127], v[200:203], v[72:75], v[112:127]
    v_mfma_f32_32x32x16_bf16 v[128:143], v[204:207], v[72:75], v[128:143]
    v_mfma_f32_32x32x16_bf16 v[144:159], v[200:203], v[76:79], v[144:159]
    v_mfma_f32_32x32x16_bf16 v[160:175], v[204:207], v[76:79], v[160:175]
    v_mfma_f32_32x32x16_bf16 v[112:127], v[208:211], v[80:83], v[112:127]
    v_mfma_f32_32x32x16_bf16 v[128:143], v[212:215], v[80:83], v[128:143]
    v_mfma_f32_32x32x16_bf16 v[144:159], v[208:211], v[84:87], v[144:159]
    v_mfma_f32_32x32x16_bf16 v[160:175], v[212:215], v[84:87], v[160:175]
    v_mfma_f32_32x32x16_bf16 v[112:127], v[216:219], v[88:91], v[112:127]
    v_mfma_f32_32x32x16_bf16 v[128:143], v[220:223], v[88:91], v[128:143]
    v_mfma_f32_32x32x16_bf16 v[144:159], v[216:219], v[92:95], v[144:159]
    v_mfma_f32_32x32x16_bf16 v[160:175], v[220:223], v[92:95], v[160:175]
    v_mfma_f32_32x32x16_bf16 v[112:127], v[224:227], v[96:99], v[112:127]
    v_mfma_f32_32x32x16_bf16 v[128:143], v[228:231], v[96:99], v[128:143]
    v_mfma_f32_32x32x16_bf16 v[144:159], v[224:227], v[100:103], v[144:159]
    v_mfma_f32_32x32x16_bf16 v[160:175], v[228:231], v[100:103], v[160:175]
    v_mfma_f32_32x32x16_bf16 v[112:127], v[232:235], v[104:107], v[112:127]
    v_mfma_f32_32x32x16_bf16 v[128:143], v[236:239], v[104:107], v[128:143]
    v_mfma_f32_32x32x16_bf16 v[144:159], v[232:235], v[108:111], v[144:159]
    v_mfma_f32_32x32x16_bf16 v[160:175], v[236:239], v[108:111], v[160:175]
    v_add_f32 v33, v33, v42
    v_add_f32 v35, v35, v44
    v_mov_b32 v41, v40
    s_nop 1
    v_permlane32_swap_b32 v32, v33
    s_nop 1
    v_add_f32 v32, v32, v33
    s_nop 1
    v_permlane32_swap_b32 v34, v35
    s_nop 1
    v_add_f32 v34, v34, v35
    s_nop 1
    v_permlane32_swap_b32 v36, v37
    s_nop 1
    v_add_f32 v36, v36, v37
    s_nop 1
    v_permlane32_swap_b32 v38, v39
    s_nop 1
    v_add_f32 v38, v38, v39
    s_nop 1
    v_permlane32_swap_b32 v40, v41
    s_nop 1
    v_add_f32 v40, v40, v41
    s_mul_i32 s67, s3, 1280
    v_lshl_add_u32 v6, v1, 2, s67
    ds_write_b32 v6, v32 offset:8192
    ds_write_b32 v6, v34 offset:8448
    ds_write_b32 v6, v36 offset:8704
    ds_write_b32 v6, v38 offset:8960
    ds_write_b32 v6, v40 offset:9216
    v_add_u32 v7, s64, v4
    v_mov_b32 v48, 0
    v_mov_b32 v49, 0
    v_mov_b32 v50, 0
    v_mov_b32 v51, 0
    ds_write_b128 v7, v[112:115] offset:16384
    ds_write_b128 v7, v[116:119] offset:17408
    ds_write_b128 v7, v[120:123] offset:18432
    ds_write_b128 v7, v[124:127] offset:19456
    s_waitcnt lgkmcnt(8)
    ds_write_b128 v7, v[128:131] offset:20480
    ds_write_b128 v7, v[132:135] offset:21504
    ds_write_b128 v7, v[136:139] offset:22528
    ds_write_b128 v7, v[140:143] offset:23552
    s_waitcnt lgkmcnt(8)
    ds_write_b128 v7, v[144:147] offset:24576
    ds_write_b128 v7, v[148:151] offset:25600
    ds_write_b128 v7, v[152:155] offset:26624
    ds_write_b128 v7, v[156:159] offset:27648
    s_waitcnt lgkmcnt(8)
    ds_write_b128 v7, v[160:163] offset:28672
    ds_write_b128 v7, v[164:167] offset:29696
    ds_write_b128 v7, v[168:171] offset:30720
    ds_write_b128 v7, v[172:175] offset:31744
    s_waitcnt lgkmcnt(8)
    s_waitcnt lgkmcnt(0)
    v_mfma_f32_32x32x16_bf16 v[144:159], v[48:51], v[48:51], 0
    v_mfma_f32_32x32x16_bf16 v[160:175], v[48:51], v[48:51], 0
    v_mfma_f32_32x32x16_bf16 v[176:191], v[48:51], v[48:51], 0
    v_mfma_f32_32x32x16_bf16 v[192:207], v[48:51], v[48:51], 0
    v_mfma_f32_32x32x16_bf16 v[208:223], v[48:51], v[48:51], 0
    v_mfma_f32_32x32x16_bf16 v[224:239], v[48:51], v[48:51], 0
    v_mfma_f32_32x32x16_bf16 v[240:255], v[48:51], v[48:51], 0
P1_B4:
    s_barrier
    s_lshr_b32 s68, s3, 1
    s_and_b32 s69, s3, 1
    v_lshlrev_b32 v6, 2, v1
    s_lshl_b32 s67, s68, 7
    v_lshl_add_u32 v7, v2, 2, s67
    ds_read_b32 v44, v6 offset:8704
    ds_read_b32 v112, v7 offset:8192
    ds_read_b32 v116, v7 offset:8448
    ds_read_b32 v45, v6 offset:9984
    ds_read_b32 v113, v7 offset:9472
    ds_read_b32 v117, v7 offset:9728
    ds_read_b32 v46, v6 offset:11264
    ds_read_b32 v114, v7 offset:10752
    ds_read_b32 v118, v7 offset:11008
    ds_read_b32 v47, v6 offset:12544
    ds_read_b32 v115, v7 offset:12032
    ds_read_b32 v119, v7 offset:12288
    s_lshl_b32 s67, s3, 12
    s_lshl_b32 s70, s19, 11
    s_add_u32 s67, s67, s70
    s_add_u32 s67, s67, 49152
    v_add_u32 v8, s67, v4
    v_add_u32 v9, 65536, v8
    s_lshl_b32 s70, s19, 10
    s_add_u32 s71, s64, s70
    v_lshl_add_u32 v10, v1, 2, s71
    s_lshl_b32 s67, s69, 7
    s_lshl_b32 s70, s19, 6
    s_add_u32 s67, s67, s70
    s_add_u32 s67, s67, s71
    v_lshl_add_u32 v11, v3, 4, s67
    s_waitcnt lgkmcnt(4)
    ds_read_b128 v[64:67], v8 offset:0
    ds_read_b128 v[68:71], v8 offset:1024
    ds_read_b128 v[72:75], v8 offset:32768
    ds_read_b128 v[76:79], v8 offset:33792
    ds_read_b128 v[80:83], v9 offset:0
    ds_read_b128 v[84:87], v9 offset:1024
    ds_read_b128 v[88:91], v9 offset:32768
    ds_read_b128 v[92:95], v9 offset:33792
    s_waitcnt lgkmcnt(8)
    v_add_f32 v44, v44, v45
    v_add_f32 v46, v46, v47
    v_add_f32 v44, v44, v46
    v_add_f32 v112, v112, v113
    v_add_f32 v114, v114, v115
    v_add_f32 v112, v112, v114
    v_add_f32 v116, v116, v117
    v_add_f32 v118, v118, v119
    v_add_f32 v116, v116, v118
    ds_write_b32 v10, v44 offset:12288
    ds_read_b128 v[56:59], v11 offset:12288
    ds_read_b128 v[60:63], v11 offset:12320
    v_mul_f32 v131, 0x3b000000, v112
    v_mul_f32 v132, 0x3b000000, v116
    v_cvt_pk_bf16_f32 v128, v131, v131
    v_and_b32 v128, 0xffff0000, v128
    v_fma_f32 v132, -v131, v131, v132
    v_max_f32 v132, 0, v132
    v_cvt_pk_bf16_f32 v132, v132, v132
    v_and_b32 v132, 0xffff0000, v132
    v_add_f32 v132, 0x3727c5ac, v132
    v_cvt_pk_bf16_f32 v132, v132, v132
    v_and_b32 v132, 0xffff0000, v132
    v_sqrt_f32 v132, v132
    s_nop 0
    v_cvt_pk_bf16_f32 v129, v132, v132
    v_and_b32 v129, 0xffff0000, v129
    v_rcp_f32 v130, v129
    s_nop 0
    s_xor_b32 s67, s68, s18
    s_lshl_b32 s67, s67, 8
    v_lshl_add_u32 v7, v2, 3, s67
    v_mov_b32 v131, v130
    v_mov_b32 v130, v128
    ds_write_b64 v7, v[130:131] offset:6912
    v_mul_f32 v132, 0x3eb8aa3b, v131
    s_waitcnt lgkmcnt(4)
    v_add_f32 v64, v64, v72
    v_add_f32 v80, v80, v88
    v_add_f32 v64, v64, v80
    v_add_f32 v65, v65, v73
    v_add_f32 v81, v81, v89
    v_add_f32 v65, v65, v81
    v_add_f32 v66, v66, v74
    v_add_f32 v82, v82, v90
    v_add_f32 v66, v66, v82
    v_add_f32 v67, v67, v75
    v_add_f32 v83, v83, v91
    v_add_f32 v67, v67, v83
    v_add_f32 v68, v68, v76
    v_add_f32 v84, v84, v92
    v_add_f32 v68, v68, v84
    v_add_f32 v69, v69, v77
    v_add_f32 v85, v85, v93
    v_add_f32 v69, v69, v85
    v_add_f32 v70, v70, v78
    v_add_f32 v86, v86, v94
    v_add_f32 v70, v70, v86
    v_add_f32 v71, v71, v79
    v_add_f32 v87, v87, v95
    v_add_f32 v71, v71, v87
    v_add_u32 v10, s71, v4
    s_waitcnt lgkmcnt(0)
    v_fma_f32 v64, -v128, v56, v64
    v_mul_f32 v64, v132, v64
    v_fma_f32 v65, -v128, v57, v65
    v_mul_f32 v65, v132, v65
    v_cvt_pk_bf16_f32 v88, v64, v65
    v_fma_f32 v66, -v128, v58, v66
    v_mul_f32 v66, v132, v66
    v_fma_f32 v67, -v128, v59, v67
    v_mul_f32 v67, v132, v67
    v_cvt_pk_bf16_f32 v89, v66, v67
    v_fma_f32 v68, -v128, v60, v68
    v_mul_f32 v68, v132, v68
    v_fma_f32 v69, -v128, v61, v69
    v_mul_f32 v69, v132, v69
    v_cvt_pk_bf16_f32 v90, v68, v69
    v_fma_f32 v70, -v128, v62, v70
    v_mul_f32 v70, v132, v70
    v_fma_f32 v71, -v128, v63, v71
    v_mul_f32 v71, v132, v71
    v_cvt_pk_bf16_f32 v91, v70, v71
    ds_write_b128 v10, v[88:91] offset:14336
    s_waitcnt vmcnt(0) lgkmcnt(0)
    s_barrier
    s_cmp_ge_u32 s60, 4
    s_cbranch_scc1 K2_H
    s_lshl_b32 s68, s60, 15
    s_add_u32 s68, s68, 0x200000
    s_mov_b32 s50, 0x0000ffff
    s_mov_b32 s51, 0x0000ffff
    s_lshl_b32 s67, s18, 16
    s_add_u32 s70, s67, 47104
    v_add_u32 v6, s70, v4
    s_xor_b32 s67, s67, 65536
    s_add_u32 s70, s67, 47104
    v_add_u32 v7, s70, v4
    ds_read_b128 v[96:99], v6 offset:0
    ds_read_b128 v[100:103], v7 offset:0
    ds_read_b128 v[104:107], v6 offset:1024
    ds_read_b128 v[108:111], v7 offset:1024
    ds_read_b128 v[112:115], v6 offset:32768
    ds_read_b128 v[116:119], v7 offset:32768
    ds_read_b128 v[120:123], v6 offset:33792
    ds_read_b128 v[124:127], v7 offset:33792
    v_and_b32 v6, 27, v2
    v_cmp_eq_u32 vcc, 16, v6
    v_mov_b32 v7, 0x3f803f80
    s_nop 0
    v_cndmask_b32 v7, 0, v7, vcc
    v_mov_b32 v24, v7
    v_mov_b32 v25, v7
    v_mov_b32 v26, v7
    v_mov_b32 v27, v7
    v_mov_b32 v28, v7
    v_mov_b32 v29, v7
    v_mov_b32 v30, v7
    v_mov_b32 v31, v7
    v_mov_b32 v32, v7
    v_mov_b32 v33, v7
    v_mov_b32 v34, v7
    v_mov_b32 v35, v7
    v_mov_b32 v36, v7
    v_mov_b32 v37, v7
    v_mov_b32 v38, v7
    v_mov_b32 v39, v7
    v_add_u32 v40, s64, v4
    v_add_u32 v41, s64, v5
    ds_read_b128 v[8:11], v40 offset:0
    s_mov_b64 exec, s[50:51]
    ds_read_b128 v[24:27], v41 offset:0
    ds_read_b128 v[28:31], v41 offset:512
    s_mov_b64 exec, -1
    v_mov_b32 v56, 0
    v_mov_b32 v57, 0
    v_mov_b32 v58, 0
    v_mov_b32 v59, 0
    v_mov_b32 v60, 0
    v_mov_b32 v61, 0
    v_mov_b32 v62, 0
    v_mov_b32 v63, 0
    v_mfma_f32_32x32x16_bf16 v[128:143], v[48:51], v[48:51], 0
    s_waitcnt lgkmcnt(0)
    v_mfma_f32_32x32x16_bf16 v[64:79], v[8:11], v[96:99], 0
    s_barrier
    s_mov_b32 s70, 8
    s_nop 7
    s_nop 1
.p2align 6
K2_LOOP:
    v_mfma_f32_32x32x16_bf16 v[80:95], v[8:11], v[100:103], 0
    v_exp_f32 v64, v64
    v_exp_f32 v65, v65
    v_exp_f32 v66, v66
    v_exp_f32 v67, v67
    v_exp_f32 v68, v68
    v_exp_f32 v69, v69
    v_mfma_f32_32x32x16_bf16 v[240:255], v[36:39], v[60:63], v[240:255]
    v_exp_f32 v70, v70
    v_exp_f32 v71, v71
    v_cvt_pk_bf16_f32 v56, v64, v65
    v_cvt_pk_bf16_f32 v57, v66, v67
    v_cvt_pk_bf16_f32 v58, v68, v69
    v_cvt_pk_bf16_f32 v59, v70, v71
    v_exp_f32 v72, v72
    v_exp_f32 v73, v73
    v_mfma_f32_32x32x16_bf16 v[128:143], v[24:27], v[56:59], v[128:143]
    v_exp_f32 v74, v74
    v_exp_f32 v75, v75
    v_exp_f32 v76, v76
    v_exp_f32 v77, v77
    v_exp_f32 v78, v78
    v_exp_f32 v79, v79
    v_cvt_pk_bf16_f32 v60, v72, v73
    v_cvt_pk_bf16_f32 v61, v74, v75
    v_cvt_pk_bf16_f32 v62, v76, v77
    v_cvt_pk_bf16_f32 v63, v78, v79
    v_mfma_f32_32x32x16_bf16 v[64:79], v[8:11], v[104:107], 0
    v_exp_f32 v80, v80
    v_exp_f32 v81, v81
    v_exp_f32 v82, v82
    v_exp_f32 v83, v83
    v_exp_f32 v84, v84
    v_exp_f32 v85, v85
    v_mfma_f32_32x32x16_bf16 v[128:143], v[28:31], v[60:63], v[128:143]
    v_exp_f32 v86, v86
    v_exp_f32 v87, v87
    v_cvt_pk_bf16_f32 v56, v80, v81
    v_cvt_pk_bf16_f32 v57, v82, v83
    v_cvt_pk_bf16_f32 v58, v84, v85
    v_cvt_pk_bf16_f32 v59, v86, v87
    v_exp_f32 v88, v88
    v_exp_f32 v89, v89
    v_mfma_f32_32x32x16_bf16 v[144:159], v[24:27], v[56:59], v[144:159]
    v_exp_f32 v90, v90
    v_exp_f32 v91, v91
    v_exp_f32 v92, v92
    v_exp_f32 v93, v93
    v_exp_f32 v94, v94
    v_exp_f32 v95, v95
    v_cvt_pk_bf16_f32 v60, v88, v89
    v_cvt_pk_bf16_f32 v61, v90, v91
    v_cvt_pk_bf16_f32 v62, v92, v93
    v_cvt_pk_bf16_f32 v63, v94, v95
    v_mfma_f32_32x32x16_bf16 v[80:95], v[8:11], v[108:111], 0
    v_exp_f32 v64, v64
    v_exp_f32 v65, v65
    v_exp_f32 v66, v66
    v_exp_f32 v67, v67
    v_exp_f32 v68, v68
    v_exp_f32 v69, v69
    v_mfma_f32_32x32x16_bf16 v[144:159], v[28:31], v[60:63], v[144:159]
    v_exp_f32 v70, v70
    v_exp_f32 v71, v71
    v_cvt_pk_bf16_f32 v56, v64, v65
    v_cvt_pk_bf16_f32 v57, v66, v67
    v_cvt_pk_bf16_f32 v58, v68, v69
    v_cvt_pk_bf16_f32 v59, v70, v71
    v_exp_f32 v72, v72
    v_exp_f32 v73, v73
    v_mfma_f32_32x32x16_bf16 v[160:175], v[24:27], v[56:59], v[160:175]
    v_exp_f32 v74, v74
    v_exp_f32 v75, v75
    v_exp_f32 v76, v76
    v_exp_f32 v77, v77
    v_exp_f32 v78, v78
    v_exp_f32 v79, v79
    v_cvt_pk_bf16_f32 v60, v72, v73
    v_cvt_pk_bf16_f32 v61, v74, v75
    v_cvt_pk_bf16_f32 v62, v76, v77
    v_cvt_pk_bf16_f32 v63, v78, v79
    v_mfma_f32_32x32x16_bf16 v[64:79], v[8:11], v[112:115], 0
    v_exp_f32 v80, v80
    v_exp_f32 v81, v81
    v_exp_f32 v82, v82
    v_exp_f32 v83, v83
    v_exp_f32 v84, v84
    v_exp_f32 v85, v85
    v_mfma_f32_32x32x16_bf16 v[160:175], v[28:31], v[60:63], v[160:175]
    v_exp_f32 v86, v86
    v_exp_f32 v87, v87
    v_cvt_pk_bf16_f32 v56, v80, v81
    v_cvt_pk_bf16_f32 v57, v82, v83
    v_cvt_pk_bf16_f32 v58, v84, v85
    v_cvt_pk_bf16_f32 v59, v86, v87
    v_exp_f32 v88, v88
    v_exp_f32 v89, v89
    v_mfma_f32_32x32x16_bf16 v[176:191], v[24:27], v[56:59], v[176:191]
    v_exp_f32 v90, v90
    v_exp_f32 v91, v91
    v_exp_f32 v92, v92
    v_exp_f32 v93, v93
    v_exp_f32 v94, v94
    v_exp_f32 v95, v95
    v_cvt_pk_bf16_f32 v60, v88, v89
    v_cvt_pk_bf16_f32 v61, v90, v91
    v_cvt_pk_bf16_f32 v62, v92, v93
    v_cvt_pk_bf16_f32 v63, v94, v95
    v_mfma_f32_32x32x16_bf16 v[80:95], v[8:11], v[116:119], 0
    v_exp_f32 v64, v64
    v_exp_f32 v65, v65
    v_exp_f32 v66, v66
    v_exp_f32 v67, v67
    v_exp_f32 v68, v68
    v_exp_f32 v69, v69
    v_mfma_f32_32x32x16_bf16 v[176:191], v[28:31], v[60:63], v[176:191]
    v_exp_f32 v70, v70
    v_exp_f32 v71, v71
    v_cvt_pk_bf16_f32 v56, v64, v65
    v_cvt_pk_bf16_f32 v57, v66, v67
    v_cvt_pk_bf16_f32 v58, v68, v69
    v_cvt_pk_bf16_f32 v59, v70, v71
    v_exp_f32 v72, v72
    v_exp_f32 v73, v73
    v_mfma_f32_32x32x16_bf16 v[192:207], v[24:27], v[56:59], v[192:207]
    v_exp_f32 v74, v74
    v_exp_f32 v75, v75
    v_exp_f32 v76, v76
    v_exp_f32 v77, v77
    v_exp_f32 v78, v78
    v_exp_f32 v79, v79
    v_cvt_pk_bf16_f32 v60, v72, v73
    v_cvt_pk_bf16_f32 v61, v74, v75
    v_cvt_pk_bf16_f32 v62, v76, v77
    v_cvt_pk_bf16_f32 v63, v78, v79
    v_mfma_f32_32x32x16_bf16 v[64:79], v[8:11], v[120:123], 0
    v_exp_f32 v80, v80
    v_exp_f32 v81, v81
    v_exp_f32 v82, v82
    v_exp_f32 v83, v83
    v_exp_f32 v84, v84
    v_exp_f32 v85, v85
    v_mfma_f32_32x32x16_bf16 v[192:207], v[28:31], v[60:63], v[192:207]
    v_exp_f32 v86, v86
    v_exp_f32 v87, v87
    ds_read_b128 v[12:15], v40 offset:2048
    s_mov_b64 exec, s[50:51]
    ds_read_b128 v[32:35], v41 offset:2048
    ds_read_b128 v[36:39], v41 offset:2560
    s_mov_b64 exec, -1
    v_cvt_pk_bf16_f32 v56, v80, v81
    v_cvt_pk_bf16_f32 v57, v82, v83
    v_cvt_pk_bf16_f32 v58, v84, v85
    v_cvt_pk_bf16_f32 v59, v86, v87
    v_exp_f32 v88, v88
    v_exp_f32 v89, v89
    v_mfma_f32_32x32x16_bf16 v[208:223], v[24:27], v[56:59], v[208:223]
    v_exp_f32 v90, v90
    v_exp_f32 v91, v91
    v_exp_f32 v92, v92
    v_exp_f32 v93, v93
    v_exp_f32 v94, v94
    v_exp_f32 v95, v95
    v_cvt_pk_bf16_f32 v60, v88, v89
    v_cvt_pk_bf16_f32 v61, v90, v91
    v_cvt_pk_bf16_f32 v62, v92, v93
    v_cvt_pk_bf16_f32 v63, v94, v95
    v_mfma_f32_32x32x16_bf16 v[80:95], v[8:11], v[124:127], 0
    v_exp_f32 v64, v64
    v_exp_f32 v65, v65
    v_exp_f32 v66, v66
    v_exp_f32 v67, v67
    v_exp_f32 v68, v68
    v_exp_f32 v69, v69
    v_mfma_f32_32x32x16_bf16 v[208:223], v[28:31], v[60:63], v[208:223]
    v_exp_f32 v70, v70
    v_exp_f32 v71, v71
    v_cvt_pk_bf16_f32 v56, v64, v65
    v_cvt_pk_bf16_f32 v57, v66, v67
    v_cvt_pk_bf16_f32 v58, v68, v69
    v_cvt_pk_bf16_f32 v59, v70, v71
    v_exp_f32 v72, v72
    v_exp_f32 v73, v73
    v_mfma_f32_32x32x16_bf16 v[224:239], v[24:27], v[56:59], v[224:239]
    v_exp_f32 v74, v74
    v_exp_f32 v75, v75
    v_exp_f32 v76, v76
    v_exp_f32 v77, v77
    v_exp_f32 v78, v78
    v_exp_f32 v79, v79
    s_waitcnt lgkmcnt(0)
    v_cvt_pk_bf16_f32 v60, v72, v73
    v_cvt_pk_bf16_f32 v61, v74, v75
    v_cvt_pk_bf16_f32 v62, v76, v77
    v_cvt_pk_bf16_f32 v63, v78, v79
    v_mfma_f32_32x32x16_bf16 v[64:79], v[12:15], v[96:99], 0
    v_exp_f32 v80, v80
    v_exp_f32 v81, v81
    v_exp_f32 v82, v82
    v_exp_f32 v83, v83
    v_exp_f32 v84, v84
    v_exp_f32 v85, v85
    v_mfma_f32_32x32x16_bf16 v[224:239], v[28:31], v[60:63], v[224:239]
    v_exp_f32 v86, v86
    v_exp_f32 v87, v87
    v_cvt_pk_bf16_f32 v56, v80, v81
    v_cvt_pk_bf16_f32 v57, v82, v83
    v_cvt_pk_bf16_f32 v58, v84, v85
    v_cvt_pk_bf16_f32 v59, v86, v87
    v_exp_f32 v88, v88
    v_exp_f32 v89, v89
    v_mfma_f32_32x32x16_bf16 v[240:255], v[24:27], v[56:59], v[240:255]
    v_exp_f32 v90, v90
    v_exp_f32 v91, v91
    v_exp_f32 v92, v92
    v_exp_f32 v93, v93
    v_exp_f32 v94, v94
    v_exp_f32 v95, v95
    v_cvt_pk_bf16_f32 v60, v88, v89
    v_cvt_pk_bf16_f32 v61, v90, v91
    v_cvt_pk_bf16_f32 v62, v92, v93
    v_cvt_pk_bf16_f32 v63, v94, v95
    v_mfma_f32_32x32x16_bf16 v[80:95], v[12:15], v[100:103], 0
    v_exp_f32 v64, v64
    v_exp_f32 v65, v65
    v_exp_f32 v66, v66
    v_exp_f32 v67, v67
    v_exp_f32 v68, v68
    v_exp_f32 v69, v69
    v_mfma_f32_32x32x16_bf16 v[240:255], v[28:31], v[60:63], v[240:255]
    v_exp_f32 v70, v70
    v_exp_f32 v71, v71
    v_cvt_pk_bf16_f32 v56, v64, v65
    v_cvt_pk_bf16_f32 v57, v66, v67
    v_cvt_pk_bf16_f32 v58, v68, v69
    v_cvt_pk_bf16_f32 v59, v70, v71
    v_exp_f32 v72, v72
    v_exp_f32 v73, v73
    v_mfma_f32_32x32x16_bf16 v[128:143], v[32:35], v[56:59], v[128:143]
    v_exp_f32 v74, v74
    v_exp_f32 v75, v75
    v_exp_f32 v76, v76
    v_exp_f32 v77, v77
    v_exp_f32 v78, v78
    v_exp_f32 v79, v79
    v_cvt_pk_bf16_f32 v60, v72, v73
    v_cvt_pk_bf16_f32 v61, v74, v75
    v_cvt_pk_bf16_f32 v62, v76, v77
    v_cvt_pk_bf16_f32 v63, v78, v79
    v_mfma_f32_32x32x16_bf16 v[64:79], v[12:15], v[104:107], 0
    v_exp_f32 v80, v80
    v_exp_f32 v81, v81
    v_exp_f32 v82, v82
    v_exp_f32 v83, v83
    v_exp_f32 v84, v84
    v_exp_f32 v85, v85
    v_mfma_f32_32x32x16_bf16 v[128:143], v[36:39], v[60:63], v[128:143]
    v_exp_f32 v86, v86
    v_exp_f32 v87, v87
    v_cvt_pk_bf16_f32 v56, v80, v81
    v_cvt_pk_bf16_f32 v57, v82, v83
    v_cvt_pk_bf16_f32 v58, v84, v85
    v_cvt_pk_bf16_f32 v59, v86, v87
    v_exp_f32 v88, v88
    v_exp_f32 v89, v89
    v_mfma_f32_32x32x16_bf16 v[144:159], v[32:35], v[56:59], v[144:159]
    v_exp_f32 v90, v90
    v_exp_f32 v91, v91
    v_exp_f32 v92, v92
    v_exp_f32 v93, v93
    v_exp_f32 v94, v94
    v_exp_f32 v95, v95
    v_cvt_pk_bf16_f32 v60, v88, v89
    v_cvt_pk_bf16_f32 v61, v90, v91
    v_cvt_pk_bf16_f32 v62, v92, v93
    v_cvt_pk_bf16_f32 v63, v94, v95
    v_mfma_f32_32x32x16_bf16 v[80:95], v[12:15], v[108:111], 0
    v_exp_f32 v64, v64
    v_exp_f32 v65, v65
    v_exp_f32 v66, v66
    v_exp_f32 v67, v67
    v_exp_f32 v68, v68
    v_exp_f32 v69, v69
    v_mfma_f32_32x32x16_bf16 v[144:159], v[36:39], v[60:63], v[144:159]
    v_exp_f32 v70, v70
    v_exp_f32 v71, v71
    v_cvt_pk_bf16_f32 v56, v64, v65
    v_cvt_pk_bf16_f32 v57, v66, v67
    v_cvt_pk_bf16_f32 v58, v68, v69
    v_cvt_pk_bf16_f32 v59, v70, v71
    v_exp_f32 v72, v72
    v_exp_f32 v73, v73
    v_mfma_f32_32x32x16_bf16 v[160:175], v[32:35], v[56:59], v[160:175]
    v_exp_f32 v74, v74
    v_exp_f32 v75, v75
    v_exp_f32 v76, v76
    v_exp_f32 v77, v77
    v_exp_f32 v78, v78
    v_exp_f32 v79, v79
    v_cvt_pk_bf16_f32 v60, v72, v73
    v_cvt_pk_bf16_f32 v61, v74, v75
    v_cvt_pk_bf16_f32 v62, v76, v77
    v_cvt_pk_bf16_f32 v63, v78, v79
    v_mfma_f32_32x32x16_bf16 v[64:79], v[12:15], v[112:115], 0
    v_exp_f32 v80, v80
    v_exp_f32 v81, v81
    v_exp_f32 v82, v82
    v_exp_f32 v83, v83
    v_exp_f32 v84, v84
    v_exp_f32 v85, v85
    v_mfma_f32_32x32x16_bf16 v[160:175], v[36:39], v[60:63], v[160:175]
    v_exp_f32 v86, v86
    v_exp_f32 v87, v87
    v_cvt_pk_bf16_f32 v56, v80, v81
    v_cvt_pk_bf16_f32 v57, v82, v83
    v_cvt_pk_bf16_f32 v58, v84, v85
    v_cvt_pk_bf16_f32 v59, v86, v87
    v_exp_f32 v88, v88
    v_exp_f32 v89, v89
    v_mfma_f32_32x32x16_bf16 v[176:191], v[32:35], v[56:59], v[176:191]
    v_exp_f32 v90, v90
    v_exp_f32 v91, v91
    v_exp_f32 v92, v92
    v_exp_f32 v93, v93
    v_exp_f32 v94, v94
    v_exp_f32 v95, v95
    v_cvt_pk_bf16_f32 v60, v88, v89
    v_cvt_pk_bf16_f32 v61, v90, v91
    v_cvt_pk_bf16_f32 v62, v92, v93
    v_cvt_pk_bf16_f32 v63, v94, v95
    v_mfma_f32_32x32x16_bf16 v[80:95], v[12:15], v[116:119], 0
    v_exp_f32 v64, v64
    v_exp_f32 v65, v65
    v_exp_f32 v66, v66
    v_exp_f32 v67, v67
    v_exp_f32 v68, v68
    v_exp_f32 v69, v69
    v_mfma_f32_32x32x16_bf16 v[176:191], v[36:39], v[60:63], v[176:191]
    v_exp_f32 v70, v70
    v_exp_f32 v71, v71
    v_cvt_pk_bf16_f32 v56, v64, v65
    v_cvt_pk_bf16_f32 v57, v66, v67
    v_cvt_pk_bf16_f32 v58, v68, v69
    v_cvt_pk_bf16_f32 v59, v70, v71
    v_exp_f32 v72, v72
    v_exp_f32 v73, v73
    v_mfma_f32_32x32x16_bf16 v[192:207], v[32:35], v[56:59], v[192:207]
    v_exp_f32 v74, v74
    v_exp_f32 v75, v75
    v_exp_f32 v76, v76
    v_exp_f32 v77, v77
    v_exp_f32 v78, v78
    v_exp_f32 v79, v79
    v_cvt_pk_bf16_f32 v60, v72, v73
    v_cvt_pk_bf16_f32 v61, v74, v75
    v_cvt_pk_bf16_f32 v62, v76, v77
    v_cvt_pk_bf16_f32 v63, v78, v79
    v_mfma_f32_32x32x16_bf16 v[64:79], v[12:15], v[120:123], 0
    v_exp_f32 v80, v80
    v_exp_f32 v81, v81
    v_exp_f32 v82, v82
    v_exp_f32 v83, v83
    v_exp_f32 v84, v84
    v_exp_f32 v85, v85
    v_mfma_f32_32x32x16_bf16 v[192:207], v[36:39], v[60:63], v[192:207]
    v_exp_f32 v86, v86
    v_exp_f32 v87, v87
    ds_read_b128 v[8:11], v40 offset:4096
    s_mov_b64 exec, s[50:51]
    ds_read_b128 v[24:27], v41 offset:4096
    ds_read_b128 v[28:31], v41 offset:4608
    s_mov_b64 exec, -1
    v_cvt_pk_bf16_f32 v56, v80, v81
    v_cvt_pk_bf16_f32 v57, v82, v83
    v_cvt_pk_bf16_f32 v58, v84, v85
    v_cvt_pk_bf16_f32 v59, v86, v87
    v_exp_f32 v88, v88
    v_exp_f32 v89, v89
    v_mfma_f32_32x32x16_bf16 v[208:223], v[32:35], v[56:59], v[208:223]
    v_exp_f32 v90, v90
    v_exp_f32 v91, v91
    v_exp_f32 v92, v92
    v_exp_f32 v93, v93
    v_exp_f32 v94, v94
    v_exp_f32 v95, v95
    v_cvt_pk_bf16_f32 v60, v88, v89
    v_cvt_pk_bf16_f32 v61, v90, v91
    v_cvt_pk_bf16_f32 v62, v92, v93
    v_cvt_pk_bf16_f32 v63, v94, v95
    v_mfma_f32_32x32x16_bf16 v[80:95], v[12:15], v[124:127], 0
    v_exp_f32 v64, v64
    v_exp_f32 v65, v65
    v_exp_f32 v66, v66
    v_exp_f32 v67, v67
    v_exp_f32 v68, v68
    v_exp_f32 v69, v69
    v_mfma_f32_32x32x16_bf16 v[208:223], v[36:39], v[60:63], v[208:223]
    v_exp_f32 v70, v70
    v_exp_f32 v71, v71
    v_cvt_pk_bf16_f32 v56, v64, v65
    v_cvt_pk_bf16_f32 v57, v66, v67
    v_cvt_pk_bf16_f32 v58, v68, v69
    v_cvt_pk_bf16_f32 v59, v70, v71
    v_exp_f32 v72, v72
    v_exp_f32 v73, v73
    v_mfma_f32_32x32x16_bf16 v[224:239], v[32:35], v[56:59], v[224:239]
    v_exp_f32 v74, v74
    v_exp_f32 v75, v75
    v_exp_f32 v76, v76
    v_exp_f32 v77, v77
    v_exp_f32 v78, v78
    v_exp_f32 v79, v79
    s_waitcnt lgkmcnt(0)
    v_cvt_pk_bf16_f32 v60, v72, v73
    v_cvt_pk_bf16_f32 v61, v74, v75
    v_cvt_pk_bf16_f32 v62, v76, v77
    v_cvt_pk_bf16_f32 v63, v78, v79
    v_mfma_f32_32x32x16_bf16 v[64:79], v[8:11], v[96:99], 0
    v_exp_f32 v80, v80
    v_exp_f32 v81, v81
    v_exp_f32 v82, v82
    v_exp_f32 v83, v83
    v_exp_f32 v84, v84
    v_exp_f32 v85, v85
    v_mfma_f32_32x32x16_bf16 v[224:239], v[36:39], v[60:63], v[224:239]
    v_exp_f32 v86, v86
    v_exp_f32 v87, v87
    v_cvt_pk_bf16_f32 v56, v80, v81
    v_cvt_pk_bf16_f32 v57, v82, v83
    v_cvt_pk_bf16_f32 v58, v84, v85
    v_cvt_pk_bf16_f32 v59, v86, v87
    v_exp_f32 v88, v88
    v_exp_f32 v89, v89
    v_mfma_f32_32x32x16_bf16 v[240:255], v[32:35], v[56:59], v[240:255]
    v_exp_f32 v90, v90
    v_exp_f32 v91, v91
    v_exp_f32 v92, v92
    v_exp_f32 v93, v93
    v_exp_f32 v94, v94
    v_exp_f32 v95, v95
    v_cvt_pk_bf16_f32 v60, v88, v89
    v_cvt_pk_bf16_f32 v61, v90, v91
    v_cvt_pk_bf16_f32 v62, v92, v93
    v_cvt_pk_bf16_f32 v63, v94, v95
    v_add_u32 v40, 4096, v40
    v_add_u32 v41, 4096, v41
    s_sub_u32 s70, s70, 1
    s_cmp_lg_u32 s70, 7
    s_cbranch_scc1 K2_LOOP_NB
    s_barrier
K2_LOOP_NB:
    s_cmp_lg_u32 s70, 0
    s_cbranch_scc1 K2_LOOP
    v_mfma_f32_32x32x16_bf16 v[240:255], v[36:39], v[60:63], v[240:255]
K2_DUMP:
    s_lshr_b32 s71, s60, 1
    s_and_b32 s72, s60, 1
    s_lshl_b32 s73, s61, 6
    s_lshl_b32 s67, s71, 5
    s_add_u32 s73, s73, s67
    v_add_u32 v56, s73, v2
    v_lshlrev_b32 v57, 10, v56
    v_lshl_add_u32 v57, v3, 5, v57
    s_lshl_b32 s74, s62, 7
    s_lshl_b32 s67, s72, 6
    s_add_u32 s74, s74, s67
    buffer_load_dwordx4 v[48:51], v57, s[20:23], s74 offen
    buffer_load_dwordx4 v[52:55], v57, s[20:23], s74 offen offset:16
    s_lshl_b32 s67, s71, 8
    v_lshl_add_u32 v58, v2, 3, s67
    ds_read_b64 v[46:47], v58 offset:6912
    s_lshl_b32 s67, s60, 15
    s_add_u32 s67, s67, 32768
    v_add_u32 v6, s67, v4
    v_lshl_add_u32 v7, v1, 2, s67
    ds_write_b128 v6, v[128:131] offset:0
    ds_write_b128 v6, v[132:135] offset:1024
    ds_write_b32 v7, v136 offset:2048
    ds_write_b128 v6, v[144:147] offset:2304
    ds_write_b128 v6, v[148:151] offset:3328
    ds_write_b32 v7, v152 offset:4352
    ds_write_b128 v6, v[160:163] offset:4608
    ds_write_b128 v6, v[164:167] offset:5632
    ds_write_b32 v7, v168 offset:6656
    ds_write_b128 v6, v[176:179] offset:6912
    ds_write_b128 v6, v[180:183] offset:7936
    ds_write_b32 v7, v184 offset:8960
    s_waitcnt lgkmcnt(9)
    ds_write_b128 v6, v[192:195] offset:9216
    ds_write_b128 v6, v[196:199] offset:10240
    ds_write_b32 v7, v200 offset:11264
    s_waitcnt lgkmcnt(9)
    ds_write_b128 v6, v[208:211] offset:11520
    ds_write_b128 v6, v[212:215] offset:12544
    ds_write_b32 v7, v216 offset:13568
    s_waitcnt lgkmcnt(9)
    ds_write_b128 v6, v[224:227] offset:13824
    ds_write_b128 v6, v[228:231] offset:14848
    ds_write_b32 v7, v232 offset:15872
    s_waitcnt lgkmcnt(9)
    ds_write_b128 v6, v[240:243] offset:16128
    ds_write_b128 v6, v[244:247] offset:17152
    ds_write_b32 v7, v248 offset:18176
    s_waitcnt lgkmcnt(9)
    s_waitcnt lgkmcnt(0)
K2_BAR1:
    s_barrier
    s_mul_i32 s67, s60, 2304
    s_add_u32 s67, s67, 32768
    v_add_u32 v6, s67, v4
    v_lshl_add_u32 v7, v1, 2, s67
    v_add_u32 v44, 65536, v6
    v_add_u32 v45, 65536, v7
    ds_read_b128 v[8:11], v6 offset:0
    ds_read_b128 v[12:15], v6 offset:1024
    ds_read_b32 v40, v7 offset:2048
    ds_read_b128 v[16:19], v6 offset:32768
    ds_read_b128 v[20:23], v6 offset:33792
    ds_read_b32 v41, v7 offset:34816
    ds_read_b128 v[24:27], v44 offset:0
    ds_read_b128 v[28:31], v44 offset:1024
    ds_read_b32 v42, v45 offset:2048
    ds_read_b128 v[32:35], v44 offset:32768
    ds_read_b128 v[36:39], v44 offset:33792
    ds_read_b32 v43, v45 offset:34816
    s_and_b32 s67, s60, 1
    s_lshl_b32 s71, s61, 1
    s_add_u32 s67, s67, s71
    s_lshl_b32 s67, s67, 5
    s_lshl_b32 s71, s62, 2
    s_add_u32 s67, s67, s71
    s_lshr_b32 s71, s60, 1
    s_add_u32 s67, s67, s71
    s_lshl_b32 s67, s67, 10
    s_add_u32 s67, s67, 0x300000
    v_mov_b32 v45, 0x37800000
    v_mov_b32 v44, 0x5f800000
    s_waitcnt lgkmcnt(0)
    v_add_f32 v40, v40, v41
    v_add_f32 v42, v42, v43
    v_add_f32 v40, v40, v42
    v_rcp_f32 v41, v40
    v_add_f32 v8, v8, v16
    v_add_f32 v24, v24, v32
    v_add_f32 v8, v8, v24
    v_add_f32 v9, v9, v17
    v_add_f32 v25, v25, v33
    v_add_f32 v9, v9, v25
    v_add_f32 v10, v10, v18
    v_add_f32 v26, v26, v34
    v_add_f32 v10, v10, v26
    v_add_f32 v11, v11, v19
    v_add_f32 v27, v27, v35
    v_add_f32 v11, v11, v27
    v_add_f32 v12, v12, v20
    v_add_f32 v28, v28, v36
    v_add_f32 v12, v12, v28
    v_add_f32 v13, v13, v21
    v_add_f32 v29, v29, v37
    v_add_f32 v13, v13, v29
    v_add_f32 v14, v14, v22
    v_add_f32 v30, v30, v38
    v_add_f32 v14, v14, v30
    v_add_f32 v15, v15, v23
    v_add_f32 v31, v31, v39
    v_add_f32 v15, v15, v31
    v_fma_f32 v42, v8, 0, v40
    v_fma_f32 v42, v9, 0, v42
    v_fma_f32 v42, v10, 0, v42
    v_fma_f32 v42, v11, 0, v42
    v_fma_f32 v42, v12, 0, v42
    v_fma_f32 v42, v13, 0, v42
    v_fma_f32 v42, v14, 0, v42
    v_fma_f32 v42, v15, 0, v42
    v_mul_f32 v8, v41, v8
    v_mul_f32 v9, v41, v9
    v_mul_f32 v10, v41, v10
    v_mul_f32 v11, v41, v11
    v_mul_f32 v12, v41, v12
    v_mul_f32 v13, v41, v13
    v_mul_f32 v14, v41, v14
    v_mul_f32 v15, v41, v15
    v_cmp_nle_f32 vcc, v45, v42
    v_cmp_nle_f32 s[72:73], v42, v44
    v_cvt_pk_bf16_f32 v16, v8, v9
    v_cvt_pk_bf16_f32 v17, v10, v11
    v_cvt_pk_bf16_f32 v18, v12, v13
    v_cvt_pk_bf16_f32 v19, v14, v15
    s_or_b64 vcc, vcc, s[72:73]
    s_waitcnt vmcnt(0)
    s_cmp_lg_u32 s59, 0
    s_cbranch_scc1 K2_STORED
    s_cmp_lg_u32 s63, 0
    s_cbranch_scc1 K2_DOSTORE
    s_cmp_eq_u64 vcc, 0
    s_cbranch_scc1 K2_DOSTORE
    v_mov_b32 v6, 1
    v_mov_b32 v7, 2580
    ds_write_b32 v7, v6
    s_branch K2_STORED
K2_DOSTORE:
    buffer_store_dwordx4 v[16:19], v4, s[44:47], s67 offen
    s_add_u32 s67, s67, 3145728
    buffer_store_dwordx4 v[16:19], v4, s[44:47], s67 offen sc1
    s_mov_b32 s59, 1
K2_STORED:
    s_waitcnt lgkmcnt(0)
    s_barrier
    s_cmp_lg_u32 s63, 0
    s_cbranch_scc1 K2_POST
    v_mov_b32 v7, 2580
    ds_read_b32 v6, v7
    s_waitcnt lgkmcnt(0)
    v_readfirstlane_b32 s67, v6
    s_nop 3
    s_cmp_lg_u32 s67, 0
    s_cbranch_scc1 K2_SLOW
K2_POST:
    s_cmp_ge_u32 s60, 4
    s_cbranch_scc1 K2_H2
    s_mul_i32 s67, s60, 6144
    s_add_u32 s67, s67, 8192
    v_add_u32 v10, s67, v4
    v_mov_b32 v7, 2560
    ds_read_b128 v[28:31], v7
    v_mov_b32 v64, 0
    v_mov_b32 v65, 0
    v_mov_b32 v66, 0
    v_mov_b32 v67, 0
    v_mov_b32 v68, 0
    v_mov_b32 v69, 0
    v_mov_b32 v70, 0
    v_mov_b32 v71, 0
    v_mov_b32 v72, 0
    v_mov_b32 v73, 0
    v_mov_b32 v74, 0
    v_mov_b32 v75, 0
    v_mov_b32 v76, 0
    v_mov_b32 v77, 0
    v_mov_b32 v78, 0
    v_mov_b32 v79, 0
    s_and_b32 s72, s60, 1
    v_lshlrev_b32 v11, 6, v3
    s_lshl_b32 s67, s72, 7
    v_add_u32 v11, s67, v11
    s_waitcnt lgkmcnt(0)
    v_cmp_eq_u32 vcc, v28, v56
    s_and_saveexec_b64 s[76:77], vcc
    s_cbranch_execz K2_NOY0
    ds_read_b128 v[64:67], v11 offset:512
    ds_read_b128 v[68:71], v11 offset:528
    ds_read_b128 v[72:75], v11 offset:544
    ds_read_b128 v[76:79], v11 offset:560
    ds_read_b128 v[80:83], v11 offset:768
    ds_read_b128 v[84:87], v11 offset:784
    ds_read_b128 v[88:91], v11 offset:800
    ds_read_b128 v[92:95], v11 offset:816
    ds_read_b128 v[96:99], v11 offset:1024
    ds_read_b128 v[100:103], v11 offset:1040
    ds_read_b128 v[104:107], v11 offset:1056
    ds_read_b128 v[108:111], v11 offset:1072
    s_waitcnt lgkmcnt(4)
    ds_read_b128 v[112:115], v11 offset:1280
    ds_read_b128 v[116:119], v11 offset:1296
    ds_read_b128 v[120:123], v11 offset:1312
    ds_read_b128 v[124:127], v11 offset:1328
    s_waitcnt lgkmcnt(0)
    v_add_f32 v64, v64, v80
    v_add_f32 v96, v96, v112
    v_add_f32 v64, v64, v96
    v_cvt_pk_bf16_f32 v64, v64, v64
    v_and_b32 v64, 0xffff0000, v64
    v_mul_f32 v64, v30, v64
    v_cvt_pk_bf16_f32 v64, v64, v64
    v_and_b32 v64, 0xffff0000, v64
    v_add_f32 v65, v65, v81
    v_add_f32 v97, v97, v113
    v_add_f32 v65, v65, v97
    v_cvt_pk_bf16_f32 v65, v65, v65
    v_and_b32 v65, 0xffff0000, v65
    v_mul_f32 v65, v30, v65
    v_cvt_pk_bf16_f32 v65, v65, v65
    v_and_b32 v65, 0xffff0000, v65
    v_add_f32 v66, v66, v82
    v_add_f32 v98, v98, v114
    v_add_f32 v66, v66, v98
    v_cvt_pk_bf16_f32 v66, v66, v66
    v_and_b32 v66, 0xffff0000, v66
    v_mul_f32 v66, v30, v66
    v_cvt_pk_bf16_f32 v66, v66, v66
    v_and_b32 v66, 0xffff0000, v66
    v_add_f32 v67, v67, v83
    v_add_f32 v99, v99, v115
    v_add_f32 v67, v67, v99
    v_cvt_pk_bf16_f32 v67, v67, v67
    v_and_b32 v67, 0xffff0000, v67
    v_mul_f32 v67, v30, v67
    v_cvt_pk_bf16_f32 v67, v67, v67
    v_and_b32 v67, 0xffff0000, v67
    v_add_f32 v68, v68, v84
    v_add_f32 v100, v100, v116
    v_add_f32 v68, v68, v100
    v_cvt_pk_bf16_f32 v68, v68, v68
    v_and_b32 v68, 0xffff0000, v68
    v_mul_f32 v68, v30, v68
    v_cvt_pk_bf16_f32 v68, v68, v68
    v_and_b32 v68, 0xffff0000, v68
    v_add_f32 v69, v69, v85
    v_add_f32 v101, v101, v117
    v_add_f32 v69, v69, v101
    v_cvt_pk_bf16_f32 v69, v69, v69
    v_and_b32 v69, 0xffff0000, v69
    v_mul_f32 v69, v30, v69
    v_cvt_pk_bf16_f32 v69, v69, v69
    v_and_b32 v69, 0xffff0000, v69
    v_add_f32 v70, v70, v86
    v_add_f32 v102, v102, v118
    v_add_f32 v70, v70, v102
    v_cvt_pk_bf16_f32 v70, v70, v70
    v_and_b32 v70, 0xffff0000, v70
    v_mul_f32 v70, v30, v70
    v_cvt_pk_bf16_f32 v70, v70, v70
    v_and_b32 v70, 0xffff0000, v70
    v_add_f32 v71, v71, v87
    v_add_f32 v103, v103, v119
    v_add_f32 v71, v71, v103
    v_cvt_pk_bf16_f32 v71, v71, v71
    v_and_b32 v71, 0xffff0000, v71
    v_mul_f32 v71, v30, v71
    v_cvt_pk_bf16_f32 v71, v71, v71
    v_and_b32 v71, 0xffff0000, v71
    v_add_f32 v72, v72, v88
    v_add_f32 v104, v104, v120
    v_add_f32 v72, v72, v104
    v_cvt_pk_bf16_f32 v72, v72, v72
    v_and_b32 v72, 0xffff0000, v72
    v_mul_f32 v72, v30, v72
    v_cvt_pk_bf16_f32 v72, v72, v72
    v_and_b32 v72, 0xffff0000, v72
    v_add_f32 v73, v73, v89
    v_add_f32 v105, v105, v121
    v_add_f32 v73, v73, v105
    v_cvt_pk_bf16_f32 v73, v73, v73
    v_and_b32 v73, 0xffff0000, v73
    v_mul_f32 v73, v30, v73
    v_cvt_pk_bf16_f32 v73, v73, v73
    v_and_b32 v73, 0xffff0000, v73
    v_add_f32 v74, v74, v90
    v_add_f32 v106, v106, v122
    v_add_f32 v74, v74, v106
    v_cvt_pk_bf16_f32 v74, v74, v74
    v_and_b32 v74, 0xffff0000, v74
    v_mul_f32 v74, v30, v74
    v_cvt_pk_bf16_f32 v74, v74, v74
    v_and_b32 v74, 0xffff0000, v74
    v_add_f32 v75, v75, v91
    v_add_f32 v107, v107, v123
    v_add_f32 v75, v75, v107
    v_cvt_pk_bf16_f32 v75, v75, v75
    v_and_b32 v75, 0xffff0000, v75
    v_mul_f32 v75, v30, v75
    v_cvt_pk_bf16_f32 v75, v75, v75
    v_and_b32 v75, 0xffff0000, v75
    v_add_f32 v76, v76, v92
    v_add_f32 v108, v108, v124
    v_add_f32 v76, v76, v108
    v_cvt_pk_bf16_f32 v76, v76, v76
    v_and_b32 v76, 0xffff0000, v76
    v_mul_f32 v76, v30, v76
    v_cvt_pk_bf16_f32 v76, v76, v76
    v_and_b32 v76, 0xffff0000, v76
    v_add_f32 v77, v77, v93
    v_add_f32 v109, v109, v125
    v_add_f32 v77, v77, v109
    v_cvt_pk_bf16_f32 v77, v77, v77
    v_and_b32 v77, 0xffff0000, v77
    v_mul_f32 v77, v30, v77
    v_cvt_pk_bf16_f32 v77, v77, v77
    v_and_b32 v77, 0xffff0000, v77
    v_add_f32 v78, v78, v94
    v_add_f32 v110, v110, v126
    v_add_f32 v78, v78, v110
    v_cvt_pk_bf16_f32 v78, v78, v78
    v_and_b32 v78, 0xffff0000, v78
    v_mul_f32 v78, v30, v78
    v_cvt_pk_bf16_f32 v78, v78, v78
    v_and_b32 v78, 0xffff0000, v78
    v_add_f32 v79, v79, v95
    v_add_f32 v111, v111, v127
    v_add_f32 v79, v79, v111
    v_cvt_pk_bf16_f32 v79, v79, v79
    v_and_b32 v79, 0xffff0000, v79
    v_mul_f32 v79, v30, v79
    v_cvt_pk_bf16_f32 v79, v79, v79
    v_and_b32 v79, 0xffff0000, v79
K2_NOY0:
    s_mov_b64 exec, -1
    v_cmp_eq_u32 vcc, v29, v56
    s_and_saveexec_b64 s[76:77], vcc
    s_cbranch_execz K2_NOY1
    ds_read_b128 v[64:67], v11 offset:1536
    ds_read_b128 v[68:71], v11 offset:1552
    ds_read_b128 v[72:75], v11 offset:1568
    ds_read_b128 v[76:79], v11 offset:1584
    ds_read_b128 v[80:83], v11 offset:1792
    ds_read_b128 v[84:87], v11 offset:1808
    ds_read_b128 v[88:91], v11 offset:1824
    ds_read_b128 v[92:95], v11 offset:1840
    ds_read_b128 v[96:99], v11 offset:2048
    ds_read_b128 v[100:103], v11 offset:2064
    ds_read_b128 v[104:107], v11 offset:2080
    ds_read_b128 v[108:111], v11 offset:2096
    s_waitcnt lgkmcnt(4)
    ds_read_b128 v[112:115], v11 offset:2304
    ds_read_b128 v[116:119], v11 offset:2320
    ds_read_b128 v[120:123], v11 offset:2336
    ds_read_b128 v[124:127], v11 offset:2352
    s_waitcnt lgkmcnt(0)
    v_add_f32 v64, v64, v80
    v_add_f32 v96, v96, v112
    v_add_f32 v64, v64, v96
    v_cvt_pk_bf16_f32 v64, v64, v64
    v_and_b32 v64, 0xffff0000, v64
    v_mul_f32 v64, v31, v64
    v_cvt_pk_bf16_f32 v64, v64, v64
    v_and_b32 v64, 0xffff0000, v64
    v_add_f32 v65, v65, v81
    v_add_f32 v97, v97, v113
    v_add_f32 v65, v65, v97
    v_cvt_pk_bf16_f32 v65, v65, v65
    v_and_b32 v65, 0xffff0000, v65
    v_mul_f32 v65, v31, v65
    v_cvt_pk_bf16_f32 v65, v65, v65
    v_and_b32 v65, 0xffff0000, v65
    v_add_f32 v66, v66, v82
    v_add_f32 v98, v98, v114
    v_add_f32 v66, v66, v98
    v_cvt_pk_bf16_f32 v66, v66, v66
    v_and_b32 v66, 0xffff0000, v66
    v_mul_f32 v66, v31, v66
    v_cvt_pk_bf16_f32 v66, v66, v66
    v_and_b32 v66, 0xffff0000, v66
    v_add_f32 v67, v67, v83
    v_add_f32 v99, v99, v115
    v_add_f32 v67, v67, v99
    v_cvt_pk_bf16_f32 v67, v67, v67
    v_and_b32 v67, 0xffff0000, v67
    v_mul_f32 v67, v31, v67
    v_cvt_pk_bf16_f32 v67, v67, v67
    v_and_b32 v67, 0xffff0000, v67
    v_add_f32 v68, v68, v84
    v_add_f32 v100, v100, v116
    v_add_f32 v68, v68, v100
    v_cvt_pk_bf16_f32 v68, v68, v68
    v_and_b32 v68, 0xffff0000, v68
    v_mul_f32 v68, v31, v68
    v_cvt_pk_bf16_f32 v68, v68, v68
    v_and_b32 v68, 0xffff0000, v68
    v_add_f32 v69, v69, v85
    v_add_f32 v101, v101, v117
    v_add_f32 v69, v69, v101
    v_cvt_pk_bf16_f32 v69, v69, v69
    v_and_b32 v69, 0xffff0000, v69
    v_mul_f32 v69, v31, v69
    v_cvt_pk_bf16_f32 v69, v69, v69
    v_and_b32 v69, 0xffff0000, v69
    v_add_f32 v70, v70, v86
    v_add_f32 v102, v102, v118
    v_add_f32 v70, v70, v102
    v_cvt_pk_bf16_f32 v70, v70, v70
    v_and_b32 v70, 0xffff0000, v70
    v_mul_f32 v70, v31, v70
    v_cvt_pk_bf16_f32 v70, v70, v70
    v_and_b32 v70, 0xffff0000, v70
    v_add_f32 v71, v71, v87
    v_add_f32 v103, v103, v119
    v_add_f32 v71, v71, v103
    v_cvt_pk_bf16_f32 v71, v71, v71
    v_and_b32 v71, 0xffff0000, v71
    v_mul_f32 v71, v31, v71
    v_cvt_pk_bf16_f32 v71, v71, v71
    v_and_b32 v71, 0xffff0000, v71
    v_add_f32 v72, v72, v88
    v_add_f32 v104, v104, v120
    v_add_f32 v72, v72, v104
    v_cvt_pk_bf16_f32 v72, v72, v72
    v_and_b32 v72, 0xffff0000, v72
    v_mul_f32 v72, v31, v72
    v_cvt_pk_bf16_f32 v72, v72, v72
    v_and_b32 v72, 0xffff0000, v72
    v_add_f32 v73, v73, v89
    v_add_f32 v105, v105, v121
    v_add_f32 v73, v73, v105
    v_cvt_pk_bf16_f32 v73, v73, v73
    v_and_b32 v73, 0xffff0000, v73
    v_mul_f32 v73, v31, v73
    v_cvt_pk_bf16_f32 v73, v73, v73
    v_and_b32 v73, 0xffff0000, v73
    v_add_f32 v74, v74, v90
    v_add_f32 v106, v106, v122
    v_add_f32 v74, v74, v106
    v_cvt_pk_bf16_f32 v74, v74, v74
    v_and_b32 v74, 0xffff0000, v74
    v_mul_f32 v74, v31, v74
    v_cvt_pk_bf16_f32 v74, v74, v74
    v_and_b32 v74, 0xffff0000, v74
    v_add_f32 v75, v75, v91
    v_add_f32 v107, v107, v123
    v_add_f32 v75, v75, v107
    v_cvt_pk_bf16_f32 v75, v75, v75
    v_and_b32 v75, 0xffff0000, v75
    v_mul_f32 v75, v31, v75
    v_cvt_pk_bf16_f32 v75, v75, v75
    v_and_b32 v75, 0xffff0000, v75
    v_add_f32 v76, v76, v92
    v_add_f32 v108, v108, v124
    v_add_f32 v76, v76, v108
    v_cvt_pk_bf16_f32 v76, v76, v76
    v_and_b32 v76, 0xffff0000, v76
    v_mul_f32 v76, v31, v76
    v_cvt_pk_bf16_f32 v76, v76, v76
    v_and_b32 v76, 0xffff0000, v76
    v_add_f32 v77, v77, v93
    v_add_f32 v109, v109, v125
    v_add_f32 v77, v77, v109
    v_cvt_pk_bf16_f32 v77, v77, v77
    v_and_b32 v77, 0xffff0000, v77
    v_mul_f32 v77, v31, v77
    v_cvt_pk_bf16_f32 v77, v77, v77
    v_and_b32 v77, 0xffff0000, v77
    v_add_f32 v78, v78, v94
    v_add_f32 v110, v110, v126
    v_add_f32 v78, v78, v110
    v_cvt_pk_bf16_f32 v78, v78, v78
    v_and_b32 v78, 0xffff0000, v78
    v_mul_f32 v78, v31, v78
    v_cvt_pk_bf16_f32 v78, v78, v78
    v_and_b32 v78, 0xffff0000, v78
    v_add_f32 v79, v79, v95
    v_add_f32 v111, v111, v127
    v_add_f32 v79, v79, v111
    v_cvt_pk_bf16_f32 v79, v79, v79
    v_and_b32 v79, 0xffff0000, v79
    v_mul_f32 v79, v31, v79
    v_cvt_pk_bf16_f32 v79, v79, v79
    v_and_b32 v79, 0xffff0000, v79
K2_NOY1:
    s_mov_b64 exec, -1
    v_lshlrev_b32 v22, 16, v48
    v_and_b32 v23, 0xffff0000, v48
    v_sub_f32 v22, v22, v46
    v_sub_f32 v23, v23, v46
    v_cvt_pk_bf16_f32 v24, v22, v23
    v_lshlrev_b32 v22, 16, v24
    v_and_b32 v23, 0xffff0000, v24
    v_mul_f32 v22, v47, v22
    v_mul_f32 v23, v47, v23
    v_cvt_pk_bf16_f32 v24, v22, v23
    v_lshlrev_b32 v22, 16, v24
    v_and_b32 v23, 0xffff0000, v24
    v_add_f32 v22, v22, v64
    v_add_f32 v23, v23, v65
    v_cvt_pk_bf16_f32 v24, v22, v23
    v_lshlrev_b32 v22, 16, v24
    v_and_b32 v23, 0xffff0000, v24
    v_mul_f32 v25, 0xbfb8aa3b, v22
    v_mul_f32 v26, 0xbfb8aa3b, v23
    v_exp_f32 v25, v25
    v_exp_f32 v26, v26
    s_nop 0
    v_add_f32 v25, 1.0, v25
    v_add_f32 v26, 1.0, v26
    v_rcp_f32 v25, v25
    v_rcp_f32 v26, v26
    s_nop 0
    v_mul_f32 v22, v25, v22
    v_mul_f32 v23, v26, v23
    v_cvt_pk_bf16_f32 v24, v22, v23
    v_lshlrev_b32 v64, 16, v24
    v_and_b32 v65, 0xffff0000, v24
    v_lshlrev_b32 v22, 16, v49
    v_and_b32 v23, 0xffff0000, v49
    v_sub_f32 v22, v22, v46
    v_sub_f32 v23, v23, v46
    v_cvt_pk_bf16_f32 v24, v22, v23
    v_lshlrev_b32 v22, 16, v24
    v_and_b32 v23, 0xffff0000, v24
    v_mul_f32 v22, v47, v22
    v_mul_f32 v23, v47, v23
    v_cvt_pk_bf16_f32 v24, v22, v23
    v_lshlrev_b32 v22, 16, v24
    v_and_b32 v23, 0xffff0000, v24
    v_add_f32 v22, v22, v66
    v_add_f32 v23, v23, v67
    v_cvt_pk_bf16_f32 v24, v22, v23
    v_lshlrev_b32 v22, 16, v24
    v_and_b32 v23, 0xffff0000, v24
    v_mul_f32 v25, 0xbfb8aa3b, v22
    v_mul_f32 v26, 0xbfb8aa3b, v23
    v_exp_f32 v25, v25
    v_exp_f32 v26, v26
    s_nop 0
    v_add_f32 v25, 1.0, v25
    v_add_f32 v26, 1.0, v26
    v_rcp_f32 v25, v25
    v_rcp_f32 v26, v26
    s_nop 0
    v_mul_f32 v22, v25, v22
    v_mul_f32 v23, v26, v23
    v_cvt_pk_bf16_f32 v24, v22, v23
    v_lshlrev_b32 v66, 16, v24
    v_and_b32 v67, 0xffff0000, v24
    ds_write_b128 v10, v[64:67] offset:0
    v_lshlrev_b32 v22, 16, v50
    v_and_b32 v23, 0xffff0000, v50
    v_sub_f32 v22, v22, v46
    v_sub_f32 v23, v23, v46
    v_cvt_pk_bf16_f32 v24, v22, v23
    v_lshlrev_b32 v22, 16, v24
    v_and_b32 v23, 0xffff0000, v24
    v_mul_f32 v22, v47, v22
    v_mul_f32 v23, v47, v23
    v_cvt_pk_bf16_f32 v24, v22, v23
    v_lshlrev_b32 v22, 16, v24
    v_and_b32 v23, 0xffff0000, v24
    v_add_f32 v22, v22, v68
    v_add_f32 v23, v23, v69
    v_cvt_pk_bf16_f32 v24, v22, v23
    v_lshlrev_b32 v22, 16, v24
    v_and_b32 v23, 0xffff0000, v24
    v_mul_f32 v25, 0xbfb8aa3b, v22
    v_mul_f32 v26, 0xbfb8aa3b, v23
    v_exp_f32 v25, v25
    v_exp_f32 v26, v26
    s_nop 0
    v_add_f32 v25, 1.0, v25
    v_add_f32 v26, 1.0, v26
    v_rcp_f32 v25, v25
    v_rcp_f32 v26, v26
    s_nop 0
    v_mul_f32 v22, v25, v22
    v_mul_f32 v23, v26, v23
    v_cvt_pk_bf16_f32 v24, v22, v23
    v_lshlrev_b32 v68, 16, v24
    v_and_b32 v69, 0xffff0000, v24
    v_lshlrev_b32 v22, 16, v51
    v_and_b32 v23, 0xffff0000, v51
    v_sub_f32 v22, v22, v46
    v_sub_f32 v23, v23, v46
    v_cvt_pk_bf16_f32 v24, v22, v23
    v_lshlrev_b32 v22, 16, v24
    v_and_b32 v23, 0xffff0000, v24
    v_mul_f32 v22, v47, v22
    v_mul_f32 v23, v47, v23
    v_cvt_pk_bf16_f32 v24, v22, v23
    v_lshlrev_b32 v22, 16, v24
    v_and_b32 v23, 0xffff0000, v24
    v_add_f32 v22, v22, v70
    v_add_f32 v23, v23, v71
    v_cvt_pk_bf16_f32 v24, v22, v23
    v_lshlrev_b32 v22, 16, v24
    v_and_b32 v23, 0xffff0000, v24
    v_mul_f32 v25, 0xbfb8aa3b, v22
    v_mul_f32 v26, 0xbfb8aa3b, v23
    v_exp_f32 v25, v25
    v_exp_f32 v26, v26
    s_nop 0
    v_add_f32 v25, 1.0, v25
    v_add_f32 v26, 1.0, v26
    v_rcp_f32 v25, v25
    v_rcp_f32 v26, v26
    s_nop 0
    v_mul_f32 v22, v25, v22
    v_mul_f32 v23, v26, v23
    v_cvt_pk_bf16_f32 v24, v22, v23
    v_lshlrev_b32 v70, 16, v24
    v_and_b32 v71, 0xffff0000, v24
    ds_write_b128 v10, v[68:71] offset:1024
    v_lshlrev_b32 v22, 16, v52
    v_and_b32 v23, 0xffff0000, v52
    v_sub_f32 v22, v22, v46
    v_sub_f32 v23, v23, v46
    v_cvt_pk_bf16_f32 v24, v22, v23
    v_lshlrev_b32 v22, 16, v24
    v_and_b32 v23, 0xffff0000, v24
    v_mul_f32 v22, v47, v22
    v_mul_f32 v23, v47, v23
    v_cvt_pk_bf16_f32 v24, v22, v23
    v_lshlrev_b32 v22, 16, v24
    v_and_b32 v23, 0xffff0000, v24
    v_add_f32 v22, v22, v72
    v_add_f32 v23, v23, v73
    v_cvt_pk_bf16_f32 v24, v22, v23
    v_lshlrev_b32 v22, 16, v24
    v_and_b32 v23, 0xffff0000, v24
    v_mul_f32 v25, 0xbfb8aa3b, v22
    v_mul_f32 v26, 0xbfb8aa3b, v23
    v_exp_f32 v25, v25
    v_exp_f32 v26, v26
    s_nop 0
    v_add_f32 v25, 1.0, v25
    v_add_f32 v26, 1.0, v26
    v_rcp_f32 v25, v25
    v_rcp_f32 v26, v26
    s_nop 0
    v_mul_f32 v22, v25, v22
    v_mul_f32 v23, v26, v23
    v_cvt_pk_bf16_f32 v24, v22, v23
    v_lshlrev_b32 v72, 16, v24
    v_and_b32 v73, 0xffff0000, v24
    v_lshlrev_b32 v22, 16, v53
    v_and_b32 v23, 0xffff0000, v53
    v_sub_f32 v22, v22, v46
    v_sub_f32 v23, v23, v46
    v_cvt_pk_bf16_f32 v24, v22, v23
    v_lshlrev_b32 v22, 16, v24
    v_and_b32 v23, 0xffff0000, v24
    v_mul_f32 v22, v47, v22
    v_mul_f32 v23, v47, v23
    v_cvt_pk_bf16_f32 v24, v22, v23
    v_lshlrev_b32 v22, 16, v24
    v_and_b32 v23, 0xffff0000, v24
    v_add_f32 v22, v22, v74
    v_add_f32 v23, v23, v75
    v_cvt_pk_bf16_f32 v24, v22, v23
    v_lshlrev_b32 v22, 16, v24
    v_and_b32 v23, 0xffff0000, v24
    v_mul_f32 v25, 0xbfb8aa3b, v22
    v_mul_f32 v26, 0xbfb8aa3b, v23
    v_exp_f32 v25, v25
    v_exp_f32 v26, v26
    s_nop 0
    v_add_f32 v25, 1.0, v25
    v_add_f32 v26, 1.0, v26
    v_rcp_f32 v25, v25
    v_rcp_f32 v26, v26
    s_nop 0
    v_mul_f32 v22, v25, v22
    v_mul_f32 v23, v26, v23
    v_cvt_pk_bf16_f32 v24, v22, v23
    v_lshlrev_b32 v74, 16, v24
    v_and_b32 v75, 0xffff0000, v24
    ds_write_b128 v10, v[72:75] offset:2048
    v_lshlrev_b32 v22, 16, v54
    v_and_b32 v23, 0xffff0000, v54
    v_sub_f32 v22, v22, v46
    v_sub_f32 v23, v23, v46
    v_cvt_pk_bf16_f32 v24, v22, v23
    v_lshlrev_b32 v22, 16, v24
    v_and_b32 v23, 0xffff0000, v24
    v_mul_f32 v22, v47, v22
    v_mul_f32 v23, v47, v23
    v_cvt_pk_bf16_f32 v24, v22, v23
    v_lshlrev_b32 v22, 16, v24
    v_and_b32 v23, 0xffff0000, v24
    v_add_f32 v22, v22, v76
    v_add_f32 v23, v23, v77
    v_cvt_pk_bf16_f32 v24, v22, v23
    v_lshlrev_b32 v22, 16, v24
    v_and_b32 v23, 0xffff0000, v24
    v_mul_f32 v25, 0xbfb8aa3b, v22
    v_mul_f32 v26, 0xbfb8aa3b, v23
    v_exp_f32 v25, v25
    v_exp_f32 v26, v26
    s_nop 0
    v_add_f32 v25, 1.0, v25
    v_add_f32 v26, 1.0, v26
    v_rcp_f32 v25, v25
    v_rcp_f32 v26, v26
    s_nop 0
    v_mul_f32 v22, v25, v22
    v_mul_f32 v23, v26, v23
    v_cvt_pk_bf16_f32 v24, v22, v23
    v_lshlrev_b32 v76, 16, v24
    v_and_b32 v77, 0xffff0000, v24
    v_lshlrev_b32 v22, 16, v55
    v_and_b32 v23, 0xffff0000, v55
    v_sub_f32 v22, v22, v46
    v_sub_f32 v23, v23, v46
    v_cvt_pk_bf16_f32 v24, v22, v23
    v_lshlrev_b32 v22, 16, v24
    v_and_b32 v23, 0xffff0000, v24
    v_mul_f32 v22, v47, v22
    v_mul_f32 v23, v47, v23
    v_cvt_pk_bf16_f32 v24, v22, v23
    v_lshlrev_b32 v22, 16, v24
    v_and_b32 v23, 0xffff0000, v24
    v_add_f32 v22, v22, v78
    v_add_f32 v23, v23, v79
    v_cvt_pk_bf16_f32 v24, v22, v23
    v_lshlrev_b32 v22, 16, v24
    v_and_b32 v23, 0xffff0000, v24
    v_mul_f32 v25, 0xbfb8aa3b, v22
    v_mul_f32 v26, 0xbfb8aa3b, v23
    v_exp_f32 v25, v25
    v_exp_f32 v26, v26
    s_nop 0
    v_add_f32 v25, 1.0, v25
    v_add_f32 v26, 1.0, v26
    v_rcp_f32 v25, v25
    v_rcp_f32 v26, v26
    s_nop 0
    v_mul_f32 v22, v25, v22
    v_mul_f32 v23, v26, v23
    v_cvt_pk_bf16_f32 v24, v22, v23
    v_lshlrev_b32 v78, 16, v24
    v_and_b32 v79, 0xffff0000, v24
    ds_write_b128 v10, v[76:79] offset:3072
    s_waitcnt lgkmcnt(0)
    s_barrier
    s_endpgm
K2_SLOW:
    s_mov_b32 s63, 1
    s_cmp_ge_u32 s60, 4
    s_cbranch_scc1 K2_SLOW_H
    v_and_b32 v6, 27, v2
    v_cmp_eq_u32 vcc, 16, v6
    v_mov_b32 v7, 0x3f803f80
    s_nop 0
    v_cndmask_b32 v7, 0, v7, vcc
    v_mov_b32 v24, v7
    v_mov_b32 v25, v7
    v_mov_b32 v26, v7
    v_mov_b32 v27, v7
    v_mov_b32 v28, v7
    v_mov_b32 v29, v7
    v_mov_b32 v30, v7
    v_mov_b32 v31, v7
    v_mov_b32 v32, v7
    v_mov_b32 v33, v7
    v_mov_b32 v34, v7
    v_mov_b32 v35, v7
    v_mov_b32 v36, v7
    v_mov_b32 v37, v7
    v_mov_b32 v38, v7
    v_mov_b32 v39, v7
    v_mov_b32 v16, 0xff7fffff
    v_mov_b32 v17, 0xff7fffff
    v_mov_b32 v18, 0xff7fffff
    v_mov_b32 v19, 0xff7fffff
    v_mov_b32 v20, 0xff7fffff
    v_mov_b32 v21, 0xff7fffff
    v_mov_b32 v22, 0xff7fffff
    v_mov_b32 v23, 0xff7fffff
    v_mov_b32 v128, 0
    v_mov_b32 v129, 0
    v_mov_b32 v130, 0
    v_mov_b32 v131, 0
    v_mov_b32 v132, 0
    v_mov_b32 v133, 0
    v_mov_b32 v134, 0
    v_mov_b32 v135, 0
    v_mov_b32 v136, 0
    v_mov_b32 v137, 0
    v_mov_b32 v138, 0
    v_mov_b32 v139, 0
    v_mov_b32 v140, 0
    v_mov_b32 v141, 0
    v_mov_b32 v142, 0
    v_mov_b32 v143, 0
    v_mov_b32 v144, 0
    v_mov_b32 v145, 0
    v_mov_b32 v146, 0
    v_mov_b32 v147, 0
    v_mov_b32 v148, 0
    v_mov_b32 v149, 0
    v_mov_b32 v150, 0
    v_mov_b32 v151, 0
    v_mov_b32 v152, 0
    v_mov_b32 v153, 0
    v_mov_b32 v154, 0
    v_mov_b32 v155, 0
    v_mov_b32 v156, 0
    v_mov_b32 v157, 0
    v_mov_b32 v158, 0
    v_mov_b32 v159, 0
    v_mov_b32 v160, 0
    v_mov_b32 v161, 0
    v_mov_b32 v162, 0
    v_mov_b32 v163, 0
    v_mov_b32 v164, 0
    v_mov_b32 v165, 0
    v_mov_b32 v166, 0
    v_mov_b32 v167, 0
    v_mov_b32 v168, 0
    v_mov_b32 v169, 0
    v_mov_b32 v170, 0
    v_mov_b32 v171, 0
    v_mov_b32 v172, 0
    v_mov_b32 v173, 0
    v_mov_b32 v174, 0
    v_mov_b32 v175, 0
    v_mov_b32 v176, 0
    v_mov_b32 v177, 0
    v_mov_b32 v178, 0
    v_mov_b32 v179, 0
    v_mov_b32 v180, 0
    v_mov_b32 v181, 0
    v_mov_b32 v182, 0
    v_mov_b32 v183, 0
    v_mov_b32 v184, 0
    v_mov_b32 v185, 0
    v_mov_b32 v186, 0
    v_mov_b32 v187, 0
    v_mov_b32 v188, 0
    v_mov_b32 v189, 0
    v_mov_b32 v190, 0
    v_mov_b32 v191, 0
    v_mov_b32 v192, 0
    v_mov_b32 v193, 0
    v_mov_b32 v194, 0
    v_mov_b32 v195, 0
    v_mov_b32 v196, 0
    v_mov_b32 v197, 0
    v_mov_b32 v198, 0
    v_mov_b32 v199, 0
    v_mov_b32 v200, 0
    v_mov_b32 v201, 0
    v_mov_b32 v202, 0
    v_mov_b32 v203, 0
    v_mov_b32 v204, 0
    v_mov_b32 v205, 0
    v_mov_b32 v206, 0
    v_mov_b32 v207, 0
    v_mov_b32 v208, 0
    v_mov_b32 v209, 0
    v_mov_b32 v210, 0
    v_mov_b32 v211, 0
    v_mov_b32 v212, 0
    v_mov_b32 v213, 0
    v_mov_b32 v214, 0
    v_mov_b32 v215, 0
    v_mov_b32 v216, 0
    v_mov_b32 v217, 0
    v_mov_b32 v218, 0
    v_mov_b32 v219, 0
    v_mov_b32 v220, 0
    v_mov_b32 v221, 0
    v_mov_b32 v222, 0
    v_mov_b32 v223, 0
    v_mov_b32 v224, 0
    v_mov_b32 v225, 0
    v_mov_b32 v226, 0
    v_mov_b32 v227, 0
    v_mov_b32 v228, 0
    v_mov_b32 v229, 0
    v_mov_b32 v230, 0
    v_mov_b32 v231, 0
    v_mov_b32 v232, 0
    v_mov_b32 v233, 0
    v_mov_b32 v234, 0
    v_mov_b32 v235, 0
    v_mov_b32 v236, 0
    v_mov_b32 v237, 0
    v_mov_b32 v238, 0
    v_mov_b32 v239, 0
    v_mov_b32 v240, 0
    v_mov_b32 v241, 0
    v_mov_b32 v242, 0
    v_mov_b32 v243, 0
    v_mov_b32 v244, 0
    v_mov_b32 v245, 0
    v_mov_b32 v246, 0
    v_mov_b32 v247, 0
    v_mov_b32 v248, 0
    v_mov_b32 v249, 0
    v_mov_b32 v250, 0
    v_mov_b32 v251, 0
    v_mov_b32 v252, 0
    v_mov_b32 v253, 0
    v_mov_b32 v254, 0
    v_mov_b32 v255, 0
    s_mov_b32 s69, s68
    s_mov_b32 s70, 16
K2_SLOW_P1:
    buffer_load_dwordx4 v[12:15], v4, s[44:47], s69 offen sc1
    s_waitcnt vmcnt(0)
    v_mfma_f32_32x32x16_bf16 v[64:79], v[12:15], v[96:99], 0
    s_nop 15
    v_max3_f32 v16, v64, v65, v16
    v_max3_f32 v16, v66, v67, v16
    v_max3_f32 v16, v68, v69, v16
    v_max3_f32 v16, v70, v71, v16
    v_max3_f32 v16, v72, v73, v16
    v_max3_f32 v16, v74, v75, v16
    v_max3_f32 v16, v76, v77, v16
    v_max3_f32 v16, v78, v79, v16
    v_mfma_f32_32x32x16_bf16 v[64:79], v[12:15], v[100:103], 0
    s_nop 15
    v_max3_f32 v17, v64, v65, v17
    v_max3_f32 v17, v66, v67, v17
    v_max3_f32 v17, v68, v69, v17
    v_max3_f32 v17, v70, v71, v17
    v_max3_f32 v17, v72, v73, v17
    v_max3_f32 v17, v74, v75, v17
    v_max3_f32 v17, v76, v77, v17
    v_max3_f32 v17, v78, v79, v17
    v_mfma_f32_32x32x16_bf16 v[64:79], v[12:15], v[104:107], 0
    s_nop 15
    v_max3_f32 v18, v64, v65, v18
    v_max3_f32 v18, v66, v67, v18
    v_max3_f32 v18, v68, v69, v18
    v_max3_f32 v18, v70, v71, v18
    v_max3_f32 v18, v72, v73, v18
    v_max3_f32 v18, v74, v75, v18
    v_max3_f32 v18, v76, v77, v18
    v_max3_f32 v18, v78, v79, v18
    v_mfma_f32_32x32x16_bf16 v[64:79], v[12:15], v[108:111], 0
    s_nop 15
    v_max3_f32 v19, v64, v65, v19
    v_max3_f32 v19, v66, v67, v19
    v_max3_f32 v19, v68, v69, v19
    v_max3_f32 v19, v70, v71, v19
    v_max3_f32 v19, v72, v73, v19
    v_max3_f32 v19, v74, v75, v19
    v_max3_f32 v19, v76, v77, v19
    v_max3_f32 v19, v78, v79, v19
    v_mfma_f32_32x32x16_bf16 v[64:79], v[12:15], v[112:115], 0
    s_nop 15
    v_max3_f32 v20, v64, v65, v20
    v_max3_f32 v20, v66, v67, v20
    v_max3_f32 v20, v68, v69, v20
    v_max3_f32 v20, v70, v71, v20
    v_max3_f32 v20, v72, v73, v20
    v_max3_f32 v20, v74, v75, v20
    v_max3_f32 v20, v76, v77, v20
    v_max3_f32 v20, v78, v79, v20
    v_mfma_f32_32x32x16_bf16 v[64:79], v[12:15], v[116:119], 0
    s_nop 15
    v_max3_f32 v21, v64, v65, v21
    v_max3_f32 v21, v66, v67, v21
    v_max3_f32 v21, v68, v69, v21
    v_max3_f32 v21, v70, v71, v21
    v_max3_f32 v21, v72, v73, v21
    v_max3_f32 v21, v74, v75, v21
    v_max3_f32 v21, v76, v77, v21
    v_max3_f32 v21, v78, v79, v21
    v_mfma_f32_32x32x16_bf16 v[64:79], v[12:15], v[120:123], 0
    s_nop 15
    v_max3_f32 v22, v64, v65, v22
    v_max3_f32 v22, v66, v67, v22
    v_max3_f32 v22, v68, v69, v22
    v_max3_f32 v22, v70, v71, v22
    v_max3_f32 v22, v72, v73, v22
    v_max3_f32 v22, v74, v75, v22
    v_max3_f32 v22, v76, v77, v22
    v_max3_f32 v22, v78, v79, v22
    v_mfma_f32_32x32x16_bf16 v[64:79], v[12:15], v[124:127], 0
    s_nop 15
    v_max3_f32 v23, v64, v65, v23
    v_max3_f32 v23, v66, v67, v23
    v_max3_f32 v23, v68, v69, v23
    v_max3_f32 v23, v70, v71, v23
    v_max3_f32 v23, v72, v73, v23
    v_max3_f32 v23, v74, v75, v23
    v_max3_f32 v23, v76, v77, v23
    v_max3_f32 v23, v78, v79, v23
    s_add_u32 s69, s69, 2048
    s_sub_u32 s70, s70, 1
    s_cmp_lg_u32 s70, 0
    s_cbranch_scc1 K2_SLOW_P1
    v_mov_b32 v42, v16
    s_nop 1
    v_permlane32_swap_b32 v16, v42
    s_nop 1
    v_max_f32 v16, v16, v42
    v_mov_b32 v42, v17
    s_nop 1
    v_permlane32_swap_b32 v17, v42
    s_nop 1
    v_max_f32 v17, v17, v42
    v_mov_b32 v42, v18
    s_nop 1
    v_permlane32_swap_b32 v18, v42
    s_nop 1
    v_max_f32 v18, v18, v42
    v_mov_b32 v42, v19
    s_nop 1
    v_permlane32_swap_b32 v19, v42
    s_nop 1
    v_max_f32 v19, v19, v42
    v_mov_b32 v42, v20
    s_nop 1
    v_permlane32_swap_b32 v20, v42
    s_nop 1
    v_max_f32 v20, v20, v42
    v_mov_b32 v42, v21
    s_nop 1
    v_permlane32_swap_b32 v21, v42
    s_nop 1
    v_max_f32 v21, v21, v42
    v_mov_b32 v42, v22
    s_nop 1
    v_permlane32_swap_b32 v22, v42
    s_nop 1
    v_max_f32 v22, v22, v42
    v_mov_b32 v42, v23
    s_nop 1
    v_permlane32_swap_b32 v23, v42
    s_nop 1
    v_max_f32 v23, v23, v42
    s_lshl_b32 s67, s60, 10
    v_lshl_add_u32 v6, v2, 2, s67
    ds_write_b32 v6, v16 offset:2592
    ds_write_b32 v6, v17 offset:2720
    ds_write_b32 v6, v18 offset:2848
    ds_write_b32 v6, v19 offset:2976
    ds_write_b32 v6, v20 offset:3104
    ds_write_b32 v6, v21 offset:3232
    ds_write_b32 v6, v22 offset:3360
    ds_write_b32 v6, v23 offset:3488
    s_waitcnt lgkmcnt(0)
    s_barrier
    v_lshlrev_b32 v6, 2, v2
    ds_read_b32 v42, v6 offset:2592
    ds_read_b32 v43, v6 offset:3616
    ds_read_b32 v44, v6 offset:4640
    ds_read_b32 v45, v6 offset:5664
    s_waitcnt lgkmcnt(0)
    v_max3_f32 v16, v42, v43, v44
    v_max_f32 v16, v16, v45
    ds_read_b32 v42, v6 offset:2720
    ds_read_b32 v43, v6 offset:3744
    ds_read_b32 v44, v6 offset:4768
    ds_read_b32 v45, v6 offset:5792
    s_waitcnt lgkmcnt(0)
    v_max3_f32 v17, v42, v43, v44
    v_max_f32 v17, v17, v45
    ds_read_b32 v42, v6 offset:2848
    ds_read_b32 v43, v6 offset:3872
    ds_read_b32 v44, v6 offset:4896
    ds_read_b32 v45, v6 offset:5920
    s_waitcnt lgkmcnt(0)
    v_max3_f32 v18, v42, v43, v44
    v_max_f32 v18, v18, v45
    ds_read_b32 v42, v6 offset:2976
    ds_read_b32 v43, v6 offset:4000
    ds_read_b32 v44, v6 offset:5024
    ds_read_b32 v45, v6 offset:6048
    s_waitcnt lgkmcnt(0)
    v_max3_f32 v19, v42, v43, v44
    v_max_f32 v19, v19, v45
    ds_read_b32 v42, v6 offset:3104
    ds_read_b32 v43, v6 offset:4128
    ds_read_b32 v44, v6 offset:5152
    ds_read_b32 v45, v6 offset:6176
    s_waitcnt lgkmcnt(0)
    v_max3_f32 v20, v42, v43, v44
    v_max_f32 v20, v20, v45
    ds_read_b32 v42, v6 offset:3232
    ds_read_b32 v43, v6 offset:4256
    ds_read_b32 v44, v6 offset:5280
    ds_read_b32 v45, v6 offset:6304
    s_waitcnt lgkmcnt(0)
    v_max3_f32 v21, v42, v43, v44
    v_max_f32 v21, v21, v45
    ds_read_b32 v42, v6 offset:3360
    ds_read_b32 v43, v6 offset:4384
    ds_read_b32 v44, v6 offset:5408
    ds_read_b32 v45, v6 offset:6432
    s_waitcnt lgkmcnt(0)
    v_max3_f32 v22, v42, v43, v44
    v_max_f32 v22, v22, v45
    ds_read_b32 v42, v6 offset:3488
    ds_read_b32 v43, v6 offset:4512
    ds_read_b32 v44, v6 offset:5536
    ds_read_b32 v45, v6 offset:6560
    s_waitcnt lgkmcnt(0)
    v_max3_f32 v23, v42, v43, v44
    v_max_f32 v23, v23, v45
    s_mov_b32 s69, s68
    s_mov_b32 s70, 16
K2_SLOW_P2:
    buffer_load_dwordx4 v[12:15], v4, s[44:47], s69 offen offset:0 sc1
    s_mov_b64 exec, s[50:51]
    buffer_load_dwordx4 v[32:35], v5, s[44:47], s69 offen offset:0 sc1
    buffer_load_dwordx4 v[36:39], v5, s[44:47], s69 offen offset:512 sc1
    s_mov_b64 exec, -1
    s_waitcnt vmcnt(0)
    v_mfma_f32_32x32x16_bf16 v[64:79], v[12:15], v[96:99], 0
    s_nop 15
    v_sub_f32 v64, v64, v16
    v_sub_f32 v65, v65, v16
    v_sub_f32 v66, v66, v16
    v_sub_f32 v67, v67, v16
    v_sub_f32 v68, v68, v16
    v_sub_f32 v69, v69, v16
    v_sub_f32 v70, v70, v16
    v_sub_f32 v71, v71, v16
    v_sub_f32 v72, v72, v16
    v_sub_f32 v73, v73, v16
    v_sub_f32 v74, v74, v16
    v_sub_f32 v75, v75, v16
    v_sub_f32 v76, v76, v16
    v_sub_f32 v77, v77, v16
    v_sub_f32 v78, v78, v16
    v_sub_f32 v79, v79, v16
    v_exp_f32 v64, v64
    v_exp_f32 v65, v65
    v_exp_f32 v66, v66
    v_exp_f32 v67, v67
    v_exp_f32 v68, v68
    v_exp_f32 v69, v69
    v_exp_f32 v70, v70
    v_exp_f32 v71, v71
    v_exp_f32 v72, v72
    v_exp_f32 v73, v73
    v_exp_f32 v74, v74
    v_exp_f32 v75, v75
    v_exp_f32 v76, v76
    v_exp_f32 v77, v77
    v_exp_f32 v78, v78
    v_exp_f32 v79, v79
    s_nop 0
    v_cvt_pk_bf16_f32 v56, v64, v65
    v_cvt_pk_bf16_f32 v57, v66, v67
    v_cvt_pk_bf16_f32 v58, v68, v69
    v_cvt_pk_bf16_f32 v59, v70, v71
    v_cvt_pk_bf16_f32 v60, v72, v73
    v_cvt_pk_bf16_f32 v61, v74, v75
    v_cvt_pk_bf16_f32 v62, v76, v77
    v_cvt_pk_bf16_f32 v63, v78, v79
    s_nop 1
    v_mfma_f32_32x32x16_bf16 v[128:143], v[32:35], v[56:59], v[128:143]
    v_mfma_f32_32x32x16_bf16 v[128:143], v[36:39], v[60:63], v[128:143]
    v_mfma_f32_32x32x16_bf16 v[64:79], v[12:15], v[100:103], 0
    s_nop 15
    v_sub_f32 v64, v64, v17
    v_sub_f32 v65, v65, v17
    v_sub_f32 v66, v66, v17
    v_sub_f32 v67, v67, v17
    v_sub_f32 v68, v68, v17
    v_sub_f32 v69, v69, v17
    v_sub_f32 v70, v70, v17
    v_sub_f32 v71, v71, v17
    v_sub_f32 v72, v72, v17
    v_sub_f32 v73, v73, v17
    v_sub_f32 v74, v74, v17
    v_sub_f32 v75, v75, v17
    v_sub_f32 v76, v76, v17
    v_sub_f32 v77, v77, v17
    v_sub_f32 v78, v78, v17
    v_sub_f32 v79, v79, v17
    v_exp_f32 v64, v64
    v_exp_f32 v65, v65
    v_exp_f32 v66, v66
    v_exp_f32 v67, v67
    v_exp_f32 v68, v68
    v_exp_f32 v69, v69
    v_exp_f32 v70, v70
    v_exp_f32 v71, v71
    v_exp_f32 v72, v72
    v_exp_f32 v73, v73
    v_exp_f32 v74, v74
    v_exp_f32 v75, v75
    v_exp_f32 v76, v76
    v_exp_f32 v77, v77
    v_exp_f32 v78, v78
    v_exp_f32 v79, v79
    s_nop 0
    v_cvt_pk_bf16_f32 v56, v64, v65
    v_cvt_pk_bf16_f32 v57, v66, v67
    v_cvt_pk_bf16_f32 v58, v68, v69
    v_cvt_pk_bf16_f32 v59, v70, v71
    v_cvt_pk_bf16_f32 v60, v72, v73
    v_cvt_pk_bf16_f32 v61, v74, v75
    v_cvt_pk_bf16_f32 v62, v76, v77
    v_cvt_pk_bf16_f32 v63, v78, v79
    s_nop 1
    v_mfma_f32_32x32x16_bf16 v[144:159], v[32:35], v[56:59], v[144:159]
    v_mfma_f32_32x32x16_bf16 v[144:159], v[36:39], v[60:63], v[144:159]
    v_mfma_f32_32x32x16_bf16 v[64:79], v[12:15], v[104:107], 0
    s_nop 15
    v_sub_f32 v64, v64, v18
    v_sub_f32 v65, v65, v18
    v_sub_f32 v66, v66, v18
    v_sub_f32 v67, v67, v18
    v_sub_f32 v68, v68, v18
    v_sub_f32 v69, v69, v18
    v_sub_f32 v70, v70, v18
    v_sub_f32 v71, v71, v18
    v_sub_f32 v72, v72, v18
    v_sub_f32 v73, v73, v18
    v_sub_f32 v74, v74, v18
    v_sub_f32 v75, v75, v18
    v_sub_f32 v76, v76, v18
    v_sub_f32 v77, v77, v18
    v_sub_f32 v78, v78, v18
    v_sub_f32 v79, v79, v18
    v_exp_f32 v64, v64
    v_exp_f32 v65, v65
    v_exp_f32 v66, v66
    v_exp_f32 v67, v67
    v_exp_f32 v68, v68
    v_exp_f32 v69, v69
    v_exp_f32 v70, v70
    v_exp_f32 v71, v71
    v_exp_f32 v72, v72
    v_exp_f32 v73, v73
    v_exp_f32 v74, v74
    v_exp_f32 v75, v75
    v_exp_f32 v76, v76
    v_exp_f32 v77, v77
    v_exp_f32 v78, v78
    v_exp_f32 v79, v79
    s_nop 0
    v_cvt_pk_bf16_f32 v56, v64, v65
    v_cvt_pk_bf16_f32 v57, v66, v67
    v_cvt_pk_bf16_f32 v58, v68, v69
    v_cvt_pk_bf16_f32 v59, v70, v71
    v_cvt_pk_bf16_f32 v60, v72, v73
    v_cvt_pk_bf16_f32 v61, v74, v75
    v_cvt_pk_bf16_f32 v62, v76, v77
    v_cvt_pk_bf16_f32 v63, v78, v79
    s_nop 1
    v_mfma_f32_32x32x16_bf16 v[160:175], v[32:35], v[56:59], v[160:175]
    v_mfma_f32_32x32x16_bf16 v[160:175], v[36:39], v[60:63], v[160:175]
    v_mfma_f32_32x32x16_bf16 v[64:79], v[12:15], v[108:111], 0
    s_nop 15
    v_sub_f32 v64, v64, v19
    v_sub_f32 v65, v65, v19
    v_sub_f32 v66, v66, v19
    v_sub_f32 v67, v67, v19
    v_sub_f32 v68, v68, v19
    v_sub_f32 v69, v69, v19
    v_sub_f32 v70, v70, v19
    v_sub_f32 v71, v71, v19
    v_sub_f32 v72, v72, v19
    v_sub_f32 v73, v73, v19
    v_sub_f32 v74, v74, v19
    v_sub_f32 v75, v75, v19
    v_sub_f32 v76, v76, v19
    v_sub_f32 v77, v77, v19
    v_sub_f32 v78, v78, v19
    v_sub_f32 v79, v79, v19
    v_exp_f32 v64, v64
    v_exp_f32 v65, v65
    v_exp_f32 v66, v66
    v_exp_f32 v67, v67
    v_exp_f32 v68, v68
    v_exp_f32 v69, v69
    v_exp_f32 v70, v70
    v_exp_f32 v71, v71
    v_exp_f32 v72, v72
    v_exp_f32 v73, v73
    v_exp_f32 v74, v74
    v_exp_f32 v75, v75
    v_exp_f32 v76, v76
    v_exp_f32 v77, v77
    v_exp_f32 v78, v78
    v_exp_f32 v79, v79
    s_nop 0
    v_cvt_pk_bf16_f32 v56, v64, v65
    v_cvt_pk_bf16_f32 v57, v66, v67
    v_cvt_pk_bf16_f32 v58, v68, v69
    v_cvt_pk_bf16_f32 v59, v70, v71
    v_cvt_pk_bf16_f32 v60, v72, v73
    v_cvt_pk_bf16_f32 v61, v74, v75
    v_cvt_pk_bf16_f32 v62, v76, v77
    v_cvt_pk_bf16_f32 v63, v78, v79
    s_nop 1
    v_mfma_f32_32x32x16_bf16 v[176:191], v[32:35], v[56:59], v[176:191]
    v_mfma_f32_32x32x16_bf16 v[176:191], v[36:39], v[60:63], v[176:191]
    v_mfma_f32_32x32x16_bf16 v[64:79], v[12:15], v[112:115], 0
    s_nop 15
    v_sub_f32 v64, v64, v20
    v_sub_f32 v65, v65, v20
    v_sub_f32 v66, v66, v20
    v_sub_f32 v67, v67, v20
    v_sub_f32 v68, v68, v20
    v_sub_f32 v69, v69, v20
    v_sub_f32 v70, v70, v20
    v_sub_f32 v71, v71, v20
    v_sub_f32 v72, v72, v20
    v_sub_f32 v73, v73, v20
    v_sub_f32 v74, v74, v20
    v_sub_f32 v75, v75, v20
    v_sub_f32 v76, v76, v20
    v_sub_f32 v77, v77, v20
    v_sub_f32 v78, v78, v20
    v_sub_f32 v79, v79, v20
    v_exp_f32 v64, v64
    v_exp_f32 v65, v65
    v_exp_f32 v66, v66
    v_exp_f32 v67, v67
    v_exp_f32 v68, v68
    v_exp_f32 v69, v69
    v_exp_f32 v70, v70
    v_exp_f32 v71, v71
    v_exp_f32 v72, v72
    v_exp_f32 v73, v73
    v_exp_f32 v74, v74
    v_exp_f32 v75, v75
    v_exp_f32 v76, v76
    v_exp_f32 v77, v77
    v_exp_f32 v78, v78
    v_exp_f32 v79, v79
    s_nop 0
    v_cvt_pk_bf16_f32 v56, v64, v65
    v_cvt_pk_bf16_f32 v57, v66, v67
    v_cvt_pk_bf16_f32 v58, v68, v69
    v_cvt_pk_bf16_f32 v59, v70, v71
    v_cvt_pk_bf16_f32 v60, v72, v73
    v_cvt_pk_bf16_f32 v61, v74, v75
    v_cvt_pk_bf16_f32 v62, v76, v77
    v_cvt_pk_bf16_f32 v63, v78, v79
    s_nop 1
    v_mfma_f32_32x32x16_bf16 v[192:207], v[32:35], v[56:59], v[192:207]
    v_mfma_f32_32x32x16_bf16 v[192:207], v[36:39], v[60:63], v[192:207]
    v_mfma_f32_32x32x16_bf16 v[64:79], v[12:15], v[116:119], 0
    s_nop 15
    v_sub_f32 v64, v64, v21
    v_sub_f32 v65, v65, v21
    v_sub_f32 v66, v66, v21
    v_sub_f32 v67, v67, v21
    v_sub_f32 v68, v68, v21
    v_sub_f32 v69, v69, v21
    v_sub_f32 v70, v70, v21
    v_sub_f32 v71, v71, v21
    v_sub_f32 v72, v72, v21
    v_sub_f32 v73, v73, v21
    v_sub_f32 v74, v74, v21
    v_sub_f32 v75, v75, v21
    v_sub_f32 v76, v76, v21
    v_sub_f32 v77, v77, v21
    v_sub_f32 v78, v78, v21
    v_sub_f32 v79, v79, v21
    v_exp_f32 v64, v64
    v_exp_f32 v65, v65
    v_exp_f32 v66, v66
    v_exp_f32 v67, v67
    v_exp_f32 v68, v68
    v_exp_f32 v69, v69
    v_exp_f32 v70, v70
    v_exp_f32 v71, v71
    v_exp_f32 v72, v72
    v_exp_f32 v73, v73
    v_exp_f32 v74, v74
    v_exp_f32 v75, v75
    v_exp_f32 v76, v76
    v_exp_f32 v77, v77
    v_exp_f32 v78, v78
    v_exp_f32 v79, v79
    s_nop 0
    v_cvt_pk_bf16_f32 v56, v64, v65
    v_cvt_pk_bf16_f32 v57, v66, v67
    v_cvt_pk_bf16_f32 v58, v68, v69
    v_cvt_pk_bf16_f32 v59, v70, v71
    v_cvt_pk_bf16_f32 v60, v72, v73
    v_cvt_pk_bf16_f32 v61, v74, v75
    v_cvt_pk_bf16_f32 v62, v76, v77
    v_cvt_pk_bf16_f32 v63, v78, v79
    s_nop 1
    v_mfma_f32_32x32x16_bf16 v[208:223], v[32:35], v[56:59], v[208:223]
    v_mfma_f32_32x32x16_bf16 v[208:223], v[36:39], v[60:63], v[208:223]
    v_mfma_f32_32x32x16_bf16 v[64:79], v[12:15], v[120:123], 0
    s_nop 15
    v_sub_f32 v64, v64, v22
    v_sub_f32 v65, v65, v22
    v_sub_f32 v66, v66, v22
    v_sub_f32 v67, v67, v22
    v_sub_f32 v68, v68, v22
    v_sub_f32 v69, v69, v22
    v_sub_f32 v70, v70, v22
    v_sub_f32 v71, v71, v22
    v_sub_f32 v72, v72, v22
    v_sub_f32 v73, v73, v22
    v_sub_f32 v74, v74, v22
    v_sub_f32 v75, v75, v22
    v_sub_f32 v76, v76, v22
    v_sub_f32 v77, v77, v22
    v_sub_f32 v78, v78, v22
    v_sub_f32 v79, v79, v22
    v_exp_f32 v64, v64
    v_exp_f32 v65, v65
    v_exp_f32 v66, v66
    v_exp_f32 v67, v67
    v_exp_f32 v68, v68
    v_exp_f32 v69, v69
    v_exp_f32 v70, v70
    v_exp_f32 v71, v71
    v_exp_f32 v72, v72
    v_exp_f32 v73, v73
    v_exp_f32 v74, v74
    v_exp_f32 v75, v75
    v_exp_f32 v76, v76
    v_exp_f32 v77, v77
    v_exp_f32 v78, v78
    v_exp_f32 v79, v79
    s_nop 0
    v_cvt_pk_bf16_f32 v56, v64, v65
    v_cvt_pk_bf16_f32 v57, v66, v67
    v_cvt_pk_bf16_f32 v58, v68, v69
    v_cvt_pk_bf16_f32 v59, v70, v71
    v_cvt_pk_bf16_f32 v60, v72, v73
    v_cvt_pk_bf16_f32 v61, v74, v75
    v_cvt_pk_bf16_f32 v62, v76, v77
    v_cvt_pk_bf16_f32 v63, v78, v79
    s_nop 1
    v_mfma_f32_32x32x16_bf16 v[224:239], v[32:35], v[56:59], v[224:239]
    v_mfma_f32_32x32x16_bf16 v[224:239], v[36:39], v[60:63], v[224:239]
    v_mfma_f32_32x32x16_bf16 v[64:79], v[12:15], v[124:127], 0
    s_nop 15
    v_sub_f32 v64, v64, v23
    v_sub_f32 v65, v65, v23
    v_sub_f32 v66, v66, v23
    v_sub_f32 v67, v67, v23
    v_sub_f32 v68, v68, v23
    v_sub_f32 v69, v69, v23
    v_sub_f32 v70, v70, v23
    v_sub_f32 v71, v71, v23
    v_sub_f32 v72, v72, v23
    v_sub_f32 v73, v73, v23
    v_sub_f32 v74, v74, v23
    v_sub_f32 v75, v75, v23
    v_sub_f32 v76, v76, v23
    v_sub_f32 v77, v77, v23
    v_sub_f32 v78, v78, v23
    v_sub_f32 v79, v79, v23
    v_exp_f32 v64, v64
    v_exp_f32 v65, v65
    v_exp_f32 v66, v66
    v_exp_f32 v67, v67
    v_exp_f32 v68, v68
    v_exp_f32 v69, v69
    v_exp_f32 v70, v70
    v_exp_f32 v71, v71
    v_exp_f32 v72, v72
    v_exp_f32 v73, v73
    v_exp_f32 v74, v74
    v_exp_f32 v75, v75
    v_exp_f32 v76, v76
    v_exp_f32 v77, v77
    v_exp_f32 v78, v78
    v_exp_f32 v79, v79
    s_nop 0
    v_cvt_pk_bf16_f32 v56, v64, v65
    v_cvt_pk_bf16_f32 v57, v66, v67
    v_cvt_pk_bf16_f32 v58, v68, v69
    v_cvt_pk_bf16_f32 v59, v70, v71
    v_cvt_pk_bf16_f32 v60, v72, v73
    v_cvt_pk_bf16_f32 v61, v74, v75
    v_cvt_pk_bf16_f32 v62, v76, v77
    v_cvt_pk_bf16_f32 v63, v78, v79
    s_nop 1
    v_mfma_f32_32x32x16_bf16 v[240:255], v[32:35], v[56:59], v[240:255]
    v_mfma_f32_32x32x16_bf16 v[240:255], v[36:39], v[60:63], v[240:255]
    s_add_u32 s69, s69, 2048
    s_sub_u32 s70, s70, 1
    s_cmp_lg_u32 s70, 0
    s_cbranch_scc1 K2_SLOW_P2
    s_nop 3
    s_branch K2_DUMP
K2_SLOW_H:
    s_barrier
    s_branch K2_BAR1
K2_H:
    s_setprio 2
    s_sub_u32 s66, s60, 4
    v_and_b32 v8, 15, v1
    v_lshrrev_b32 v9, 4, v1
    s_lshl_b32 s67, s62, 2
    s_add_u32 s81, s67, s66
    s_cmp_lg_u32 s81, 17
    s_cbranch_scc1 K2_H_NOR1
    v_lshlrev_b32 v6, 2, v1
    ds_read_b32 v112, v6 offset:8192
    ds_read_b32 v113, v6 offset:9472
    ds_read_b32 v114, v6 offset:10752
    ds_read_b32 v115, v6 offset:12032
    ds_read_b32 v116, v6 offset:8448
    ds_read_b32 v117, v6 offset:9728
    ds_read_b32 v118, v6 offset:11008
    ds_read_b32 v119, v6 offset:12288
    ds_read_b32 v120, v6 offset:8960
    ds_read_b32 v121, v6 offset:10240
    ds_read_b32 v122, v6 offset:11520
    ds_read_b32 v123, v6 offset:12800
    s_waitcnt lgkmcnt(4)
    ds_read_b32 v124, v6 offset:9216
    ds_read_b32 v125, v6 offset:10496
    ds_read_b32 v126, v6 offset:11776
    ds_read_b32 v127, v6 offset:13056
    s_waitcnt lgkmcnt(0)
K2_H_NOR1:
    s_mul_i32 s64, s56, 28
    s_add_u32 s64, s64, s57
    s_mul_i32 s65, s66, 6144
    s_add_u32 s65, s65, 8192
    s_cmp_lt_u32 s66, 2
    s_cselect_b32 s52, s28, s32
    s_cselect_b32 s53, s29, s33
    s_mov_b32 s54, 0x1c0000
    s_mov_b32 s55, 0x00020000
    s_lshr_b32 s48, s64, 3
    s_and_b32 s49, s64, 7
    s_lshl_b32 s49, s49, 1
    s_and_b32 s67, s66, 1
    s_add_u32 s49, s49, s67
    v_lshrrev_b32 v6, 3, v1
    v_and_b32 v12, 7, v1
    v_lshlrev_b32 v12, 4, v12
    s_movk_i32 s67, 3584
    v_mad_u32_u24 v16, v6, s67, v12
    v_lshlrev_b32 v17, 10, v9
    v_lshl_add_u32 v17, v8, 4, v17
    v_lshl_add_u32 v12, v6, 10, v12
    v_bfe_u32 v13, v1, 2, 2
    v_lshl_add_u32 v13, v3, 2, v13
    v_lshlrev_b32 v13, 7, v13
    v_and_b32 v14, 1, v1
    v_lshl_add_u32 v13, v14, 5, v13
    v_bfe_u32 v14, v1, 4, 1
    v_lshl_add_u32 v13, v14, 4, v13
    v_bfe_u32 v14, v1, 1, 1
    v_lshl_add_u32 v13, v14, 3, v13
    v_add_u32 v13, s65, v13
    s_and_b32 s77, s66, 1
    s_lshl_b32 s67, s77, 6
    v_add_u32 v13, s67, v13
    v_xor_b32 v29, 64, v13
    s_lshl_b32 s69, s77, 18
    s_lshl_b32 s67, s62, 7
    s_add_u32 s69, s69, s67
    s_lshl_b32 s74, s66, 15
    s_add_u32 s75, s74, 0x200000
    s_add_u32 s74, s74, 32768
    s_barrier
    s_add_u32 m0, s74, 8192
    s_add_u32 s67, s75, 8192
    buffer_load_dwordx4 v4, s[44:47], s67 offen offset:0 sc1 lds
    buffer_load_dwordx4 v4, s[44:47], s67 offen offset:1024 sc1 lds
    buffer_load_dwordx4 v4, s[44:47], s67 offen offset:2048 sc1 lds
    buffer_load_dwordx4 v4, s[44:47], s67 offen offset:3072 sc1 lds
    s_add_u32 m0, s74, 12288
    s_add_u32 s67, s75, 12288
    buffer_load_dwordx4 v4, s[44:47], s67 offen offset:0 sc1 lds
    buffer_load_dwordx4 v4, s[44:47], s67 offen offset:1024 sc1 lds
    buffer_load_dwordx4 v4, s[44:47], s67 offen offset:2048 sc1 lds
    buffer_load_dwordx4 v4, s[44:47], s67 offen offset:3072 sc1 lds
    s_add_u32 m0, s74, 16384
    s_add_u32 s67, s75, 16384
    buffer_load_dwordx4 v4, s[44:47], s67 offen offset:0 sc1 lds
    buffer_load_dwordx4 v4, s[44:47], s67 offen offset:1024 sc1 lds
    buffer_load_dwordx4 v4, s[44:47], s67 offen offset:2048 sc1 lds
    buffer_load_dwordx4 v4, s[44:47], s67 offen offset:3072 sc1 lds
    s_add_u32 m0, s74, 20480
    s_add_u32 s67, s75, 20480
    buffer_load_dwordx4 v4, s[44:47], s67 offen offset:0 sc1 lds
    buffer_load_dwordx4 v4, s[44:47], s67 offen offset:1024 sc1 lds
    buffer_load_dwordx4 v4, s[44:47], s67 offen offset:2048 sc1 lds
    buffer_load_dwordx4 v4, s[44:47], s67 offen offset:3072 sc1 lds
    s_add_u32 m0, s74, 24576
    s_add_u32 s67, s75, 24576
    buffer_load_dwordx4 v4, s[44:47], s67 offen offset:0 sc1 lds
    buffer_load_dwordx4 v4, s[44:47], s67 offen offset:1024 sc1 lds
    buffer_load_dwordx4 v4, s[44:47], s67 offen offset:2048 sc1 lds
    buffer_load_dwordx4 v4, s[44:47], s67 offen offset:3072 sc1 lds
    s_add_u32 m0, s74, 28672
    s_add_u32 s67, s75, 28672
    buffer_load_dwordx4 v4, s[44:47], s67 offen offset:0 sc1 lds
    buffer_load_dwordx4 v4, s[44:47], s67 offen offset:1024 sc1 lds
    buffer_load_dwordx4 v4, s[44:47], s67 offen offset:2048 sc1 lds
    buffer_load_dwordx4 v4, s[44:47], s67 offen offset:3072 sc1 lds
    s_cmp_lg_u32 s81, 17
    s_cbranch_scc1 K2_H_NOR2
    v_add_f32 v112, v112, v113
    v_add_f32 v114, v114, v115
    v_add_f32 v112, v112, v114
    v_add_f32 v116, v116, v117
    v_add_f32 v118, v118, v119
    v_add_f32 v116, v116, v118
    v_add_f32 v120, v120, v121
    v_add_f32 v122, v122, v123
    v_add_f32 v120, v120, v122
    v_add_f32 v124, v124, v125
    v_add_f32 v126, v126, v127
    v_add_f32 v124, v124, v126
    v_mul_f32 v131, 0x3b000000, v112
    v_mul_f32 v132, 0x3b000000, v116
    v_cvt_pk_bf16_f32 v128, v131, v131
    v_and_b32 v128, 0xffff0000, v128
    v_fma_f32 v132, -v131, v131, v132
    v_max_f32 v132, 0, v132
    v_cvt_pk_bf16_f32 v132, v132, v132
    v_and_b32 v132, 0xffff0000, v132
    v_add_f32 v132, 0x3727c5ac, v132
    v_cvt_pk_bf16_f32 v132, v132, v132
    v_and_b32 v132, 0xffff0000, v132
    v_sqrt_f32 v132, v132
    s_nop 0
    v_cvt_pk_bf16_f32 v129, v132, v132
    v_and_b32 v129, 0xffff0000, v129
    v_rcp_f32 v130, v129
    s_nop 0
    v_readlane_b32 s67, v124, 0
    s_nop 1
    v_mul_f32 v18, s67, v128
    v_sub_f32 v120, v120, v18
    v_mul_f32 v120, v130, v120
    v_cvt_pk_bf16_f32 v120, v120, v120
    v_and_b32 v120, 0xffff0000, v120
    v_ashrrev_i32 v18, 31, v120
    v_or_b32 v18, 0x80000000, v18
    v_xor_b32 v120, v120, v18
    v_and_b32 v120, 0xffff0000, v120
    s_lshl_b32 s67, s61, 6
    v_add_u32 v19, s67, v1
    v_sub_u32 v18, 0xffff, v19
    v_or_b32 v120, v120, v18
    v_lshlrev_b32 v19, 3, v19
    s_mov_b32 s67, 0x221000
    buffer_store_dwordx2 v[128:129], v19, s[44:47], s67 offen sc1
    v_mov_b32 v24, v120
    s_nop 1
    v_max_u32_dpp v24, v24, v24 row_shr:1 row_mask:0xf bank_mask:0xf bound_ctrl:0
    s_nop 1
    v_max_u32_dpp v24, v24, v24 row_shr:2 row_mask:0xf bank_mask:0xf bound_ctrl:0
    s_nop 1
    v_max_u32_dpp v24, v24, v24 row_shr:4 row_mask:0xf bank_mask:0xf bound_ctrl:0
    s_nop 1
    v_max_u32_dpp v24, v24, v24 row_shr:8 row_mask:0xf bank_mask:0xf bound_ctrl:0
    s_nop 1
    v_max_u32_dpp v24, v24, v24 row_bcast:15 row_mask:0xa bank_mask:0xf
    s_nop 1
    v_max_u32_dpp v24, v24, v24 row_bcast:31 row_mask:0xc bank_mask:0xf
    s_nop 1
    v_readlane_b32 s70, v24, 63
    s_nop 1
    v_cmp_ne_u32 vcc, s70, v120
    s_nop 1
    v_cndmask_b32 v24, 0, v120, vcc
    s_nop 1
    v_max_u32_dpp v24, v24, v24 row_shr:1 row_mask:0xf bank_mask:0xf bound_ctrl:0
    s_nop 1
    v_max_u32_dpp v24, v24, v24 row_shr:2 row_mask:0xf bank_mask:0xf bound_ctrl:0
    s_nop 1
    v_max_u32_dpp v24, v24, v24 row_shr:4 row_mask:0xf bank_mask:0xf bound_ctrl:0
    s_nop 1
    v_max_u32_dpp v24, v24, v24 row_shr:8 row_mask:0xf bank_mask:0xf bound_ctrl:0
    s_nop 1
    v_max_u32_dpp v24, v24, v24 row_bcast:15 row_mask:0xa bank_mask:0xf
    s_nop 1
    v_max_u32_dpp v24, v24, v24 row_bcast:31 row_mask:0xc bank_mask:0xf
    s_nop 1
    v_readlane_b32 s71, v24, 63
    s_nop 1
    v_mov_b32 v20, s70
    v_mov_b32 v21, s71
    v_mov_b32 v22, s80
    v_mov_b32 v23, s80
    s_lshl_b32 s67, s61, 4
    s_add_u32 s67, s67, 0x220000
    v_mov_b32 v18, 0
    s_waitcnt vmcnt(0)
    s_mov_b64 exec, 1
    buffer_store_dwordx4 v[20:23], v18, s[44:47], s67 offen sc1
    s_mov_b64 exec, -1
K2_H_NOR2:
    s_waitcnt vmcnt(0)
    s_barrier
    v_lshlrev_b32 v6, 4, v2
    s_mov_b32 s67, 0x220000
    s_mov_b32 s76, 0x40000
K2_H_SPINK:
    buffer_load_dwordx4 v[20:23], v6, s[44:47], s67 offen sc1
    s_waitcnt vmcnt(0)
    v_cmp_ne_u32 vcc, s80, v22
    v_cmp_ne_u32 s[72:73], s80, v23
    s_or_b64 vcc, vcc, s[72:73]
    s_cmp_eq_u64 vcc, 0
    s_cbranch_scc1 K2_H_SPINK_DONE
    s_sleep 16
    s_sub_u32 s76, s76, 1
    s_cmp_lg_u32 s76, 0
    s_cbranch_scc1 K2_H_SPINK
K2_H_SPINK_DONE:
    v_mov_b32 v10, v20
    v_mov_b32 v11, v21
    v_mov_b32 v18, v10
    s_nop 1
    v_max_u32_dpp v18, v18, v18 row_shr:1 row_mask:0xf bank_mask:0xf bound_ctrl:0
    s_nop 1
    v_max_u32_dpp v18, v18, v18 row_shr:2 row_mask:0xf bank_mask:0xf bound_ctrl:0
    s_nop 1
    v_max_u32_dpp v18, v18, v18 row_shr:4 row_mask:0xf bank_mask:0xf bound_ctrl:0
    s_nop 1
    v_max_u32_dpp v18, v18, v18 row_shr:8 row_mask:0xf bank_mask:0xf bound_ctrl:0
    s_nop 1
    v_max_u32_dpp v18, v18, v18 row_bcast:15 row_mask:0xa bank_mask:0xf
    s_nop 1
    v_max_u32_dpp v18, v18, v18 row_bcast:31 row_mask:0xc bank_mask:0xf
    s_nop 1
    v_readlane_b32 s70, v18, 63
    s_nop 1
    v_cmp_eq_u32 vcc, s70, v10
    s_nop 1
    v_cndmask_b32 v18, v10, v11, vcc
    s_nop 1
    v_max_u32_dpp v18, v18, v18 row_shr:1 row_mask:0xf bank_mask:0xf bound_ctrl:0
    s_nop 1
    v_max_u32_dpp v18, v18, v18 row_shr:2 row_mask:0xf bank_mask:0xf bound_ctrl:0
    s_nop 1
    v_max_u32_dpp v18, v18, v18 row_shr:4 row_mask:0xf bank_mask:0xf bound_ctrl:0
    s_nop 1
    v_max_u32_dpp v18, v18, v18 row_shr:8 row_mask:0xf bank_mask:0xf bound_ctrl:0
    s_nop 1
    v_max_u32_dpp v18, v18, v18 row_bcast:15 row_mask:0xa bank_mask:0xf
    s_nop 1
    v_max_u32_dpp v18, v18, v18 row_bcast:31 row_mask:0xc bank_mask:0xf
    s_nop 1
    v_readlane_b32 s71, v18, 63
    s_nop 3
    s_and_b32 s72, s70, 0xffff
    s_sub_u32 s72, 0xffff, s72
    s_and_b32 s73, s71, 0xffff
    s_sub_u32 s73, 0xffff, s73
    s_and_b32 s72, s72, 2047
    s_and_b32 s73, s73, 2047
    s_cmp_lt_u32 s57, 28
    s_cbranch_scc1 K2_H_FFN
    s_add_u32 m0, s65, 0
    s_add_u32 s67, s69, 0
    buffer_load_dwordx4 v12, s[24:27], s67 offen offset:0 lds
    s_add_u32 s67, s69, 7168
    buffer_load_dwordx4 v12, s[24:27], s67 offen offset:1024 lds
    s_add_u32 s67, s69, 14336
    buffer_load_dwordx4 v12, s[24:27], s67 offen offset:2048 lds
    s_add_u32 s67, s69, 21504
    buffer_load_dwordx4 v12, s[24:27], s67 offen offset:3072 lds
    s_add_u32 m0, s65, 4096
    s_add_u32 s67, s69, 32768
    buffer_load_dwordx4 v12, s[24:27], s67 offen offset:0 lds
    s_add_u32 s67, s69, 39936
    buffer_load_dwordx4 v12, s[24:27], s67 offen offset:1024 lds
    s_waitcnt vmcnt(0)
    ds_read_b64_tr_b16 v[128:129], v13 offset:0
    ds_read_b64_tr_b16 v[130:131], v13 offset:1024
    ds_read_b64_tr_b16 v[132:133], v29 offset:0
    ds_read_b64_tr_b16 v[134:135], v29 offset:1024
    ds_read_b64_tr_b16 v[136:137], v13 offset:2048
    ds_read_b64_tr_b16 v[138:139], v13 offset:3072
    ds_read_b64_tr_b16 v[140:141], v29 offset:2048
    ds_read_b64_tr_b16 v[142:143], v29 offset:3072
    ds_read_b64_tr_b16 v[144:145], v13 offset:4096
    ds_read_b64_tr_b16 v[146:147], v13 offset:5120
    ds_read_b64_tr_b16 v[148:149], v29 offset:4096
    ds_read_b64_tr_b16 v[150:151], v29 offset:5120
    s_waitcnt lgkmcnt(0)
    s_add_u32 m0, s65, 0
    s_add_u32 s67, s69, 49152
    buffer_load_dwordx4 v12, s[24:27], s67 offen offset:0 lds
    s_add_u32 s67, s69, 56320
    buffer_load_dwordx4 v12, s[24:27], s67 offen offset:1024 lds
    s_add_u32 s67, s69, 63488
    buffer_load_dwordx4 v12, s[24:27], s67 offen offset:2048 lds
    s_add_u32 s67, s69, 70656
    buffer_load_dwordx4 v12, s[24:27], s67 offen offset:3072 lds
    s_add_u32 m0, s65, 4096
    s_add_u32 s67, s69, 81920
    buffer_load_dwordx4 v12, s[24:27], s67 offen offset:0 lds
    s_add_u32 s67, s69, 89088
    buffer_load_dwordx4 v12, s[24:27], s67 offen offset:1024 lds
    s_waitcnt vmcnt(0)
    ds_read_b64_tr_b16 v[152:153], v13 offset:0
    ds_read_b64_tr_b16 v[154:155], v13 offset:1024
    ds_read_b64_tr_b16 v[156:157], v29 offset:0
    ds_read_b64_tr_b16 v[158:159], v29 offset:1024
    ds_read_b64_tr_b16 v[160:161], v13 offset:2048
    ds_read_b64_tr_b16 v[162:163], v13 offset:3072
    ds_read_b64_tr_b16 v[164:165], v29 offset:2048
    ds_read_b64_tr_b16 v[166:167], v29 offset:3072
    ds_read_b64_tr_b16 v[168:169], v13 offset:4096
    ds_read_b64_tr_b16 v[170:171], v13 offset:5120
    ds_read_b64_tr_b16 v[172:173], v29 offset:4096
    ds_read_b64_tr_b16 v[174:175], v29 offset:5120
    s_waitcnt lgkmcnt(0)
    s_branch K2_H_NOFFN1
K2_H_FFN:
    v_mov_b32 v18, s72
    v_mov_b32 v19, s73
    v_cmp_eq_u32 vcc, 0, v3
    s_lshl_b32 s67, s49, 6
    s_nop 0
    v_cndmask_b32 v18, v19, v18, vcc
    v_lshlrev_b32 v19, 10, v18
    v_lshl_add_u32 v19, v2, 1, v19
    buffer_load_ushort v20, v19, s[20:23], s67 offen
    v_lshlrev_b32 v19, 3, v18
    s_mov_b32 s67, 0x221000
    buffer_load_dwordx2 v[22:23], v19, s[44:47], s67 offen sc1
    s_mul_i32 s68, s49, 114688
    s_lshl_b32 s67, s48, 7
    s_add_u32 s68, s68, s67
    s_add_u32 m0, s65, 0
    s_add_u32 s67, s68, 0
    buffer_load_dwordx4 v16, s[52:55], s67 offen lds
    s_add_u32 m0, s65, 1024
    s_add_u32 s67, s68, 28672
    buffer_load_dwordx4 v16, s[52:55], s67 offen lds
    s_add_u32 m0, s65, 2048
    s_add_u32 s67, s68, 57344
    buffer_load_dwordx4 v16, s[52:55], s67 offen lds
    s_add_u32 m0, s65, 3072
    s_add_u32 s67, s68, 86016
    buffer_load_dwordx4 v16, s[52:55], s67 offen lds
    s_lshl_b32 s68, s64, 13
    s_lshl_b32 s67, s66, 8
    s_add_u32 s68, s68, s67
    s_add_u32 m0, s65, 4096
    s_add_u32 s67, s68, 0
    buffer_load_dwordx4 v17, s[36:39], s67 offen lds
    s_add_u32 m0, s65, 5120
    s_add_u32 s67, s68, 4096
    buffer_load_dwordx4 v17, s[36:39], s67 offen lds
    v_bfe_u32 v24, v1, 2, 2
    v_lshl_add_u32 v25, v9, 3, v24
    v_lshlrev_b32 v25, 7, v25
    v_and_b32 v26, 3, v1
    v_lshl_add_u32 v25, v26, 3, v25
    v_add_u32 v25, s65, v25
    v_and_b32 v24, 1, v24
    v_lshl_add_u32 v24, v9, 1, v24
    v_lshlrev_b32 v24, 8, v24
    v_lshl_add_u32 v24, v26, 3, v24
    v_add_u32 v24, s65, v24
    s_lshl_b32 s67, s66, 7
    v_lshl_add_u32 v27, v1, 1, s67
    v_and_b32 v28, 1, v8
    v_lshlrev_b32 v28, 6, v28
    v_lshl_add_u32 v28, v9, 4, v28
    v_add_u32 v28, s67, v28
    s_waitcnt vmcnt(6)
    v_rcp_f32 v23, v23
    v_lshlrev_b32 v20, 16, v20
    v_sub_f32 v20, v20, v22
    v_cvt_pk_bf16_f32 v20, v20, v20
    v_and_b32 v20, 0xffff0000, v20
    v_mul_f32 v20, v23, v20
    v_cvt_pk_bf16_f32 v20, v20, v20
    ds_write_b16 v27, v20 offset:0
    ds_read_b128 v[80:83], v28 offset:0
    s_waitcnt vmcnt(2)
    ds_read_b64_tr_b16 v[64:65], v25 offset:0
    ds_read_b64_tr_b16 v[66:67], v25 offset:512
    ds_read_b64_tr_b16 v[68:69], v25 offset:32
    ds_read_b64_tr_b16 v[70:71], v25 offset:544
    ds_read_b64_tr_b16 v[72:73], v25 offset:64
    ds_read_b64_tr_b16 v[74:75], v25 offset:576
    ds_read_b64_tr_b16 v[76:77], v25 offset:96
    ds_read_b64_tr_b16 v[78:79], v25 offset:608
    s_movk_i32 s67, 7168
    v_mul_lo_u32 v19, v8, s67
    v_lshl_add_u32 v19, v9, 4, v19
    s_lshl_b32 s67, s49, 1
    s_lshr_b32 s74, s66, 1
    s_add_u32 s67, s67, s74
    s_mul_i32 s67, s67, 14336
    s_lshl_b32 s74, s48, 8
    s_add_u32 s67, s67, s74
    s_add_u32 s75, s67, 0x240000
    v_mov_b32 v26, s80
    v_mov_b32 v18, 0
    s_waitcnt lgkmcnt(0)
    v_mfma_f32_16x16x32_bf16 v[48:51], v[64:67], v[80:83], 0
    v_mfma_f32_16x16x32_bf16 v[52:55], v[68:71], v[80:83], 0
    v_mfma_f32_16x16x32_bf16 v[56:59], v[72:75], v[80:83], 0
    v_mfma_f32_16x16x32_bf16 v[60:63], v[76:79], v[80:83], 0
    s_mov_b32 exec_lo, 0x00030003
    s_mov_b32 exec_hi, 0x00030003
    s_nop 5
    buffer_store_dwordx4 v[48:51], v19, s[44:47], s75 offen offset:0 sc1
    buffer_store_dwordx4 v[52:55], v19, s[44:47], s75 offen offset:64 sc1
    buffer_store_dwordx4 v[56:59], v19, s[44:47], s75 offen offset:128 sc1
    buffer_store_dwordx4 v[60:63], v19, s[44:47], s75 offen offset:192 sc1
    s_mov_b64 exec, -1
    s_waitcnt vmcnt(4)
    ds_read_b64_tr_b16 v[96:97], v24 offset:4096
    v_mov_b32 v98, 0
    v_mov_b32 v99, 0
    ds_read_b64_tr_b16 v[100:101], v24 offset:4128
    v_mov_b32 v102, 0
    v_mov_b32 v103, 0
    ds_read_b64_tr_b16 v[104:105], v24 offset:4160
    v_mov_b32 v106, 0
    v_mov_b32 v107, 0
    ds_read_b64_tr_b16 v[108:109], v24 offset:4192
    v_mov_b32 v110, 0
    v_mov_b32 v111, 0
    ds_read_b64_tr_b16 v[112:113], v24 offset:4224
    v_mov_b32 v114, 0
    v_mov_b32 v115, 0
    ds_read_b64_tr_b16 v[116:117], v24 offset:4256
    v_mov_b32 v118, 0
    v_mov_b32 v119, 0
    ds_read_b64_tr_b16 v[120:121], v24 offset:4288
    v_mov_b32 v122, 0
    v_mov_b32 v123, 0
    ds_read_b64_tr_b16 v[124:125], v24 offset:4320
    v_mov_b32 v126, 0
    v_mov_b32 v127, 0
    s_lshl_b32 s67, s64, 4
    s_lshl_b32 s74, s66, 2
    s_add_u32 s67, s67, s74
    s_add_u32 s67, s67, 0x227000
    s_waitcnt vmcnt(0)
    s_mov_b64 exec, 1
    buffer_store_dword v26, v18, s[44:47], s67 offen sc1
    s_mov_b64 exec, -1
    s_waitcnt lgkmcnt(0)
    s_add_u32 m0, s65, 0
    s_add_u32 s67, s69, 0
    buffer_load_dwordx4 v12, s[24:27], s67 offen offset:0 lds
    s_add_u32 s67, s69, 7168
    buffer_load_dwordx4 v12, s[24:27], s67 offen offset:1024 lds
    s_add_u32 s67, s69, 14336
    buffer_load_dwordx4 v12, s[24:27], s67 offen offset:2048 lds
    s_add_u32 s67, s69, 21504
    buffer_load_dwordx4 v12, s[24:27], s67 offen offset:3072 lds
    s_add_u32 m0, s65, 4096
    s_add_u32 s67, s69, 32768
    buffer_load_dwordx4 v12, s[24:27], s67 offen offset:0 lds
    s_add_u32 s67, s69, 39936
    buffer_load_dwordx4 v12, s[24:27], s67 offen offset:1024 lds
    s_waitcnt vmcnt(0)
    ds_read_b64_tr_b16 v[128:129], v13 offset:0
    ds_read_b64_tr_b16 v[130:131], v13 offset:1024
    ds_read_b64_tr_b16 v[132:133], v29 offset:0
    ds_read_b64_tr_b16 v[134:135], v29 offset:1024
    ds_read_b64_tr_b16 v[136:137], v13 offset:2048
    ds_read_b64_tr_b16 v[138:139], v13 offset:3072
    ds_read_b64_tr_b16 v[140:141], v29 offset:2048
    ds_read_b64_tr_b16 v[142:143], v29 offset:3072
    ds_read_b64_tr_b16 v[144:145], v13 offset:4096
    ds_read_b64_tr_b16 v[146:147], v13 offset:5120
    ds_read_b64_tr_b16 v[148:149], v29 offset:4096
    ds_read_b64_tr_b16 v[150:151], v29 offset:5120
    s_waitcnt lgkmcnt(0)
    s_add_u32 m0, s65, 0
    s_add_u32 s67, s69, 49152
    buffer_load_dwordx4 v12, s[24:27], s67 offen offset:0 lds
    s_add_u32 s67, s69, 56320
    buffer_load_dwordx4 v12, s[24:27], s67 offen offset:1024 lds
    s_add_u32 s67, s69, 63488
    buffer_load_dwordx4 v12, s[24:27], s67 offen offset:2048 lds
    s_add_u32 s67, s69, 70656
    buffer_load_dwordx4 v12, s[24:27], s67 offen offset:3072 lds
    s_add_u32 m0, s65, 4096
    s_add_u32 s67, s69, 81920
    buffer_load_dwordx4 v12, s[24:27], s67 offen offset:0 lds
    s_add_u32 s67, s69, 89088
    buffer_load_dwordx4 v12, s[24:27], s67 offen offset:1024 lds
    s_waitcnt vmcnt(0)
    ds_read_b64_tr_b16 v[152:153], v13 offset:0
    ds_read_b64_tr_b16 v[154:155], v13 offset:1024
    ds_read_b64_tr_b16 v[156:157], v29 offset:0
    ds_read_b64_tr_b16 v[158:159], v29 offset:1024
    ds_read_b64_tr_b16 v[160:161], v13 offset:2048
    ds_read_b64_tr_b16 v[162:163], v13 offset:3072
    ds_read_b64_tr_b16 v[164:165], v29 offset:2048
    ds_read_b64_tr_b16 v[166:167], v29 offset:3072
    ds_read_b64_tr_b16 v[168:169], v13 offset:4096
    ds_read_b64_tr_b16 v[170:171], v13 offset:5120
    ds_read_b64_tr_b16 v[172:173], v29 offset:4096
    ds_read_b64_tr_b16 v[174:175], v29 offset:5120
    s_waitcnt lgkmcnt(0)
    s_mov_b32 exec_hi, 0
    v_lshlrev_b32 v18, 2, v1
    s_lshl_b32 s67, s48, 7
    s_add_u32 s67, s67, 0x227000
    s_mov_b32 s76, 0x40000
K2_H_SPIN1:
    buffer_load_dword v19, v18, s[44:47], s67 offen sc1
    s_waitcnt vmcnt(0)
    v_cmp_ne_u32 vcc, s80, v19
    s_cmp_eq_u64 vcc, 0
    s_cbranch_scc1 K2_H_SPIN1_DONE
    s_sleep 8
    s_sub_u32 s76, s76, 1
    s_cmp_lg_u32 s76, 0
    s_cbranch_scc1 K2_H_SPIN1
K2_H_SPIN1_DONE:
    s_mov_b64 exec, -1
    v_lshrrev_b32 v18, 1, v8
    s_mov_b32 s67, 57344
    v_mul_lo_u32 v18, v18, s67
    v_and_b32 v19, 1, v8
    s_movk_i32 s67, 7168
    v_mad_u32_u24 v18, v19, s67, v18
    v_lshl_add_u32 v18, v9, 3, v18
    s_lshl_b32 s74, s64, 5
    s_add_u32 s74, s74, 0x240000
    s_add_u32 s67, s74, 0
    buffer_load_dwordx2 v[64:65], v18, s[44:47], s67 offen sc1
    s_add_u32 s67, s74, 14336
    buffer_load_dwordx2 v[66:67], v18, s[44:47], s67 offen sc1
    s_add_u32 s67, s74, 28672
    buffer_load_dwordx2 v[68:69], v18, s[44:47], s67 offen sc1
    s_add_u32 s67, s74, 43008
    buffer_load_dwordx2 v[70:71], v18, s[44:47], s67 offen sc1
    v_mov_b32 v41, 0
    v_mov_b32 v42, 0
    v_mov_b32 v43, 0
    s_waitcnt vmcnt(0) lgkmcnt(0)
    v_add_f32 v64, v64, v68
    v_add_f32 v65, v65, v69
    v_add_f32 v66, v66, v70
    v_add_f32 v67, v67, v71
    s_nop 0
    v_add_f32_dpp v64, v64, v64 row_ror:2 row_mask:0xf bank_mask:0xf
    v_add_f32_dpp v65, v65, v65 row_ror:2 row_mask:0xf bank_mask:0xf
    v_add_f32_dpp v66, v66, v66 row_ror:2 row_mask:0xf bank_mask:0xf
    v_add_f32_dpp v67, v67, v67 row_ror:2 row_mask:0xf bank_mask:0xf
    s_nop 0
    v_add_f32_dpp v64, v64, v64 row_ror:4 row_mask:0xf bank_mask:0xf
    v_add_f32_dpp v65, v65, v65 row_ror:4 row_mask:0xf bank_mask:0xf
    v_add_f32_dpp v66, v66, v66 row_ror:4 row_mask:0xf bank_mask:0xf
    v_add_f32_dpp v67, v67, v67 row_ror:4 row_mask:0xf bank_mask:0xf
    s_nop 0
    v_add_f32_dpp v64, v64, v64 row_ror:8 row_mask:0xf bank_mask:0xf
    v_add_f32_dpp v65, v65, v65 row_ror:8 row_mask:0xf bank_mask:0xf
    v_add_f32_dpp v66, v66, v66 row_ror:8 row_mask:0xf bank_mask:0xf
    v_add_f32_dpp v67, v67, v67 row_ror:8 row_mask:0xf bank_mask:0xf
    v_cvt_pk_bf16_f32 v24, v64, v65
    v_cvt_pk_bf16_f32 v25, v66, v67
    v_lshlrev_b32 v64, 16, v24
    v_and_b32 v65, 0xffff0000, v24
    v_lshlrev_b32 v66, 16, v25
    v_and_b32 v67, 0xffff0000, v25
    v_mul_f32 v24, 0xbfb8aa3b, v64
    v_mul_f32 v25, 0xbfb8aa3b, v65
    v_exp_f32 v24, v24
    v_exp_f32 v25, v25
    s_nop 0
    v_add_f32 v24, 1.0, v24
    v_add_f32 v25, 1.0, v25
    v_rcp_f32 v24, v24
    v_rcp_f32 v25, v25
    s_nop 0
    v_mul_f32 v64, v24, v64
    v_mul_f32 v65, v25, v65
    v_cvt_pk_bf16_f32 v24, v64, v65
    v_lshlrev_b32 v64, 16, v24
    v_and_b32 v65, 0xffff0000, v24
    v_mul_f32 v64, v64, v66
    v_mul_f32 v65, v65, v67
    v_cvt_pk_bf16_f32 v40, v64, v65
    v_lshlrev_b32 v19, 11, v8
    v_lshl_add_u32 v19, v9, 4, v19
    v_mfma_f32_16x16x32_bf16 v[64:67], v[96:99], v[40:43], 0
    v_mfma_f32_16x16x32_bf16 v[68:71], v[100:103], v[40:43], 0
    v_mfma_f32_16x16x32_bf16 v[72:75], v[104:107], v[40:43], 0
    v_mfma_f32_16x16x32_bf16 v[76:79], v[108:111], v[40:43], 0
    v_mfma_f32_16x16x32_bf16 v[80:83], v[112:115], v[40:43], 0
    v_mfma_f32_16x16x32_bf16 v[84:87], v[116:119], v[40:43], 0
    v_mfma_f32_16x16x32_bf16 v[88:91], v[120:123], v[40:43], 0
    v_mfma_f32_16x16x32_bf16 v[92:95], v[124:127], v[40:43], 0
    s_lshl_b32 s67, s64, 12
    s_lshl_b32 s74, s66, 9
    s_add_u32 s67, s67, s74
    s_add_u32 s67, s67, 0x500000
    s_mov_b32 exec_lo, 0x00030003
    s_mov_b32 exec_hi, 0x00030003
    s_nop 3
    buffer_store_dwordx4 v[64:67], v19, s[44:47], s67 offen offset:0 sc1
    buffer_store_dwordx4 v[68:71], v19, s[44:47], s67 offen offset:64 sc1
    buffer_store_dwordx4 v[72:75], v19, s[44:47], s67 offen offset:128 sc1
    buffer_store_dwordx4 v[76:79], v19, s[44:47], s67 offen offset:192 sc1
    buffer_store_dwordx4 v[80:83], v19, s[44:47], s67 offen offset:256 sc1
    buffer_store_dwordx4 v[84:87], v19, s[44:47], s67 offen offset:320 sc1
    buffer_store_dwordx4 v[88:91], v19, s[44:47], s67 offen offset:384 sc1
    buffer_store_dwordx4 v[92:95], v19, s[44:47], s67 offen offset:448 sc1
    s_lshl_b32 s67, s66, 10
    s_lshl_b32 s74, s64, 2
    s_add_u32 s67, s67, s74
    s_add_u32 s67, s67, 0x226000
    s_mov_b64 exec, 1
    v_mov_b32 v18, 0
    s_waitcnt vmcnt(0)
    buffer_store_dword v26, v18, s[44:47], s67 offen sc1
    s_mov_b64 exec, -1
K2_H_NOFFN1:
    v_mov_b32 v20, -1
    v_mov_b32 v21, -1
    v_mov_b32 v22, -1
    v_mov_b32 v23, -1
    s_lshl_b32 s67, s61, 6
    s_lshl_b32 s74, s62, 2
    s_add_u32 s67, s67, s74
    s_add_u32 s67, s67, s66
    s_lshl_b32 s67, s67, 10
    s_add_u32 s67, s67, 0x300000
    s_add_u32 s74, s67, 0
    buffer_store_dwordx4 v[20:23], v4, s[44:47], s74 offen sc1
    s_add_u32 s74, s67, 32768
    buffer_store_dwordx4 v[20:23], v4, s[44:47], s74 offen sc1
    s_add_u32 s74, s67, 3145728
    buffer_store_dwordx4 v[20:23], v4, s[44:47], s74 offen sc1
    s_add_u32 s74, s67, 3178496
    buffer_store_dwordx4 v[20:23], v4, s[44:47], s74 offen sc1
    s_lshl_b32 s67, s61, 3
    s_add_u32 s67, s67, s62
    s_lshl_b32 s67, s67, 2
    s_add_u32 s67, s67, s66
    s_lshl_b32 s67, s67, 2
    s_add_u32 s67, s67, 0x2b8000
    v_mov_b32 v18, 0
    v_mov_b32 v19, s80
    s_waitcnt vmcnt(0)
    s_mov_b64 exec, 1
    buffer_store_dword v19, v18, s[44:47], s67 offen sc1
    s_mov_b64 exec, -1
    s_add_u32 m0, s65, 0
    s_add_u32 s67, s69, 98304
    buffer_load_dwordx4 v12, s[24:27], s67 offen offset:0 lds
    s_add_u32 s67, s69, 105472
    buffer_load_dwordx4 v12, s[24:27], s67 offen offset:1024 lds
    s_add_u32 s67, s69, 112640
    buffer_load_dwordx4 v12, s[24:27], s67 offen offset:2048 lds
    s_add_u32 s67, s69, 119808
    buffer_load_dwordx4 v12, s[24:27], s67 offen offset:3072 lds
    s_add_u32 m0, s65, 4096
    s_add_u32 s67, s69, 131072
    buffer_load_dwordx4 v12, s[24:27], s67 offen offset:0 lds
    s_add_u32 s67, s69, 138240
    buffer_load_dwordx4 v12, s[24:27], s67 offen offset:1024 lds
    s_waitcnt vmcnt(0)
    ds_read_b64_tr_b16 v[176:177], v13 offset:0
    ds_read_b64_tr_b16 v[178:179], v13 offset:1024
    ds_read_b64_tr_b16 v[180:181], v29 offset:0
    ds_read_b64_tr_b16 v[182:183], v29 offset:1024
    ds_read_b64_tr_b16 v[184:185], v13 offset:2048
    ds_read_b64_tr_b16 v[186:187], v13 offset:3072
    ds_read_b64_tr_b16 v[188:189], v29 offset:2048
    ds_read_b64_tr_b16 v[190:191], v29 offset:3072
    ds_read_b64_tr_b16 v[192:193], v13 offset:4096
    ds_read_b64_tr_b16 v[194:195], v13 offset:5120
    ds_read_b64_tr_b16 v[196:197], v29 offset:4096
    ds_read_b64_tr_b16 v[198:199], v29 offset:5120
    s_waitcnt lgkmcnt(0)
    s_add_u32 m0, s65, 0
    s_add_u32 s67, s69, 147456
    buffer_load_dwordx4 v12, s[24:27], s67 offen offset:0 lds
    s_add_u32 s67, s69, 154624
    buffer_load_dwordx4 v12, s[24:27], s67 offen offset:1024 lds
    s_add_u32 s67, s69, 161792
    buffer_load_dwordx4 v12, s[24:27], s67 offen offset:2048 lds
    s_add_u32 s67, s69, 168960
    buffer_load_dwordx4 v12, s[24:27], s67 offen offset:3072 lds
    s_add_u32 m0, s65, 4096
    s_add_u32 s67, s69, 180224
    buffer_load_dwordx4 v12, s[24:27], s67 offen offset:0 lds
    s_add_u32 s67, s69, 187392
    buffer_load_dwordx4 v12, s[24:27], s67 offen offset:1024 lds
    s_waitcnt vmcnt(0)
    ds_read_b64_tr_b16 v[200:201], v13 offset:0
    ds_read_b64_tr_b16 v[202:203], v13 offset:1024
    ds_read_b64_tr_b16 v[204:205], v29 offset:0
    ds_read_b64_tr_b16 v[206:207], v29 offset:1024
    ds_read_b64_tr_b16 v[208:209], v13 offset:2048
    ds_read_b64_tr_b16 v[210:211], v13 offset:3072
    ds_read_b64_tr_b16 v[212:213], v29 offset:2048
    ds_read_b64_tr_b16 v[214:215], v29 offset:3072
    ds_read_b64_tr_b16 v[216:217], v13 offset:4096
    ds_read_b64_tr_b16 v[218:219], v13 offset:5120
    ds_read_b64_tr_b16 v[220:221], v29 offset:4096
    ds_read_b64_tr_b16 v[222:223], v29 offset:5120
    s_waitcnt lgkmcnt(0)
    s_add_u32 m0, s65, 0
    s_add_u32 s67, s69, 196608
    buffer_load_dwordx4 v12, s[24:27], s67 offen offset:0 lds
    s_add_u32 s67, s69, 203776
    buffer_load_dwordx4 v12, s[24:27], s67 offen offset:1024 lds
    s_add_u32 s67, s69, 210944
    buffer_load_dwordx4 v12, s[24:27], s67 offen offset:2048 lds
    s_add_u32 s67, s69, 218112
    buffer_load_dwordx4 v12, s[24:27], s67 offen offset:3072 lds
    s_add_u32 m0, s65, 4096
    s_add_u32 s67, s69, 229376
    buffer_load_dwordx4 v12, s[24:27], s67 offen offset:0 lds
    s_add_u32 s67, s69, 236544
    buffer_load_dwordx4 v12, s[24:27], s67 offen offset:1024 lds
    s_waitcnt vmcnt(0)
    ds_read_b64_tr_b16 v[224:225], v13 offset:0
    ds_read_b64_tr_b16 v[226:227], v13 offset:1024
    ds_read_b64_tr_b16 v[228:229], v29 offset:0
    ds_read_b64_tr_b16 v[230:231], v29 offset:1024
    ds_read_b64_tr_b16 v[232:233], v13 offset:2048
    ds_read_b64_tr_b16 v[234:235], v13 offset:3072
    ds_read_b64_tr_b16 v[236:237], v29 offset:2048
    ds_read_b64_tr_b16 v[238:239], v29 offset:3072
    ds_read_b64_tr_b16 v[240:241], v13 offset:4096
    ds_read_b64_tr_b16 v[242:243], v13 offset:5120
    ds_read_b64_tr_b16 v[244:245], v29 offset:4096
    ds_read_b64_tr_b16 v[246:247], v29 offset:5120
    s_waitcnt lgkmcnt(0)
    s_add_u32 m0, s65, 0
    s_add_u32 s67, s69, 245760
    buffer_load_dwordx4 v12, s[24:27], s67 offen offset:0 lds
    s_add_u32 s67, s69, 252928
    buffer_load_dwordx4 v12, s[24:27], s67 offen offset:1024 lds
    s_waitcnt vmcnt(0)
    ds_read_b64_tr_b16 v[248:249], v13 offset:0
    ds_read_b64_tr_b16 v[250:251], v13 offset:1024
    ds_read_b64_tr_b16 v[252:253], v29 offset:0
    ds_read_b64_tr_b16 v[254:255], v29 offset:1024
    s_waitcnt lgkmcnt(0)
    s_lshr_b32 s74, s66, 1
    s_lshl_b32 s75, s61, 1
    s_add_u32 s75, s75, s74
    s_lshl_b32 s67, s75, 5
    v_add_u32 v15, s67, v2
    v_lshlrev_b32 v14, 10, v15
    v_lshl_add_u32 v14, v3, 5, v14
    s_lshl_b32 s58, s62, 7
    s_lshl_b32 s67, s77, 6
    s_add_u32 s58, s58, s67
    buffer_load_dwordx4 v[120:123], v14, s[20:23], s58 offen
    buffer_load_dwordx4 v[124:127], v14, s[20:23], s58 offen offset:16
    s_cmp_lg_u32 s66, 0
    s_cbranch_scc1 K2_H_NOSEL
    s_and_b32 s74, s70, 0xffff0000
    s_mov_b32 s76, 0xffff0000
    s_cmp_lt_i32 s74, 0
    s_cselect_b32 s76, 0x80000000, s76
    s_xor_b32 s74, s74, s76
    v_mov_b32 v22, s74
    v_mul_f32 v22, 0xbfb8aa3b, v22
    v_exp_f32 v22, v22
    s_nop 0
    v_add_f32 v22, 1.0, v22
    v_rcp_f32 v22, v22
    s_nop 0
    v_cvt_pk_bf16_f32 v22, v22, v22
    v_and_b32 v22, 0xffff0000, v22
    s_and_b32 s74, s71, 0xffff0000
    s_mov_b32 s76, 0xffff0000
    s_cmp_lt_i32 s74, 0
    s_cselect_b32 s76, 0x80000000, s76
    s_xor_b32 s74, s74, s76
    v_mov_b32 v23, s74
    v_mul_f32 v23, 0xbfb8aa3b, v23
    v_exp_f32 v23, v23
    s_nop 0
    v_add_f32 v23, 1.0, v23
    v_rcp_f32 v23, v23
    s_nop 0
    v_cvt_pk_bf16_f32 v23, v23, v23
    v_and_b32 v23, 0xffff0000, v23
    v_mov_b32 v20, s72
    v_mov_b32 v21, s73
    v_mov_b32 v18, 2560
    ds_write_b128 v18, v[20:23]
K2_H_NOSEL:
    s_lshr_b32 s67, s72, 6
    s_cmp_lg_u32 s67, s61
    s_cbranch_scc1 K2_H_NOCONS0
    s_lshr_b32 s67, s62, 1
    s_lshl_b32 s67, s67, 10
    s_mul_i32 s74, s66, 224
    s_add_u32 s67, s67, s74
    s_add_u32 s67, s67, 0x226000
    v_lshlrev_b32 v18, 2, v1
    s_mov_b32 s76, 0x40000
    s_mov_b32 exec_hi, 0x00ffffff
K2_H_SPIN2_0:
    buffer_load_dword v19, v18, s[44:47], s67 offen sc1
    s_waitcnt vmcnt(0)
    v_cmp_ne_u32 vcc, s80, v19
    s_cmp_eq_u64 vcc, 0
    s_cbranch_scc1 K2_H_SPIN2_DONE0
    s_sleep 8
    s_sub_u32 s76, s76, 1
    s_cmp_lg_u32 s76, 0
    s_cbranch_scc1 K2_H_SPIN2_0
K2_H_SPIN2_DONE0:
    s_mov_b64 exec, -1
    v_lshlrev_b32 v18, 12, v9
    v_lshl_add_u32 v18, v8, 4, v18
    s_mul_i32 s67, s66, 229376
    s_lshl_b32 s74, s62, 8
    s_add_u32 s67, s67, s74
    s_add_u32 s67, s67, 0x500000
    buffer_load_dwordx4 v[64:67], v18, s[44:47], s67 offen sc1
    s_add_u32 s67, s67, 16384
    buffer_load_dwordx4 v[68:71], v18, s[44:47], s67 offen sc1
    s_add_u32 s67, s67, 16384
    buffer_load_dwordx4 v[72:75], v18, s[44:47], s67 offen sc1
    s_add_u32 s67, s67, 16384
    buffer_load_dwordx4 v[76:79], v18, s[44:47], s67 offen sc1
    s_add_u32 s67, s67, 16384
    buffer_load_dwordx4 v[80:83], v18, s[44:47], s67 offen sc1
    s_add_u32 s67, s67, 16384
    buffer_load_dwordx4 v[84:87], v18, s[44:47], s67 offen sc1
    s_add_u32 s67, s67, 16384
    buffer_load_dwordx4 v[88:91], v18, s[44:47], s67 offen sc1
    s_add_u32 s67, s67, 16384
    buffer_load_dwordx4 v[92:95], v18, s[44:47], s67 offen sc1
    s_add_u32 s67, s67, 16384
    buffer_load_dwordx4 v[96:99], v18, s[44:47], s67 offen sc1
    s_add_u32 s67, s67, 16384
    buffer_load_dwordx4 v[100:103], v18, s[44:47], s67 offen sc1
    s_add_u32 s67, s67, 16384
    buffer_load_dwordx4 v[104:107], v18, s[44:47], s67 offen sc1
    s_add_u32 s67, s67, 16384
    buffer_load_dwordx4 v[108:111], v18, s[44:47], s67 offen sc1
    s_add_u32 s67, s67, 16384
    buffer_load_dwordx4 v[112:115], v18, s[44:47], s67 offen sc1
    s_add_u32 s67, s67, 16384
    buffer_load_dwordx4 v[116:119], v18, s[44:47], s67 offen sc1
    s_add_u32 s67, s67, 16384
    s_waitcnt vmcnt(0)
    v_add_f32 v64, v64, v68
    v_add_f32 v65, v65, v69
    v_add_f32 v66, v66, v70
    v_add_f32 v67, v67, v71
    v_add_f32 v64, v64, v72
    v_add_f32 v65, v65, v73
    v_add_f32 v66, v66, v74
    v_add_f32 v67, v67, v75
    v_add_f32 v64, v64, v76
    v_add_f32 v65, v65, v77
    v_add_f32 v66, v66, v78
    v_add_f32 v67, v67, v79
    v_add_f32 v64, v64, v80
    v_add_f32 v65, v65, v81
    v_add_f32 v66, v66, v82
    v_add_f32 v67, v67, v83
    v_add_f32 v64, v64, v84
    v_add_f32 v65, v65, v85
    v_add_f32 v66, v66, v86
    v_add_f32 v67, v67, v87
    v_add_f32 v64, v64, v88
    v_add_f32 v65, v65, v89
    v_add_f32 v66, v66, v90
    v_add_f32 v67, v67, v91
    v_add_f32 v64, v64, v92
    v_add_f32 v65, v65, v93
    v_add_f32 v66, v66, v94
    v_add_f32 v67, v67, v95
    v_add_f32 v64, v64, v96
    v_add_f32 v65, v65, v97
    v_add_f32 v66, v66, v98
    v_add_f32 v67, v67, v99
    v_add_f32 v64, v64, v100
    v_add_f32 v65, v65, v101
    v_add_f32 v66, v66, v102
    v_add_f32 v67, v67, v103
    v_add_f32 v64, v64, v104
    v_add_f32 v65, v65, v105
    v_add_f32 v66, v66, v106
    v_add_f32 v67, v67, v107
    v_add_f32 v64, v64, v108
    v_add_f32 v65, v65, v109
    v_add_f32 v66, v66, v110
    v_add_f32 v67, v67, v111
    v_add_f32 v64, v64, v112
    v_add_f32 v65, v65, v113
    v_add_f32 v66, v66, v114
    v_add_f32 v67, v67, v115
    v_add_f32 v64, v64, v116
    v_add_f32 v65, v65, v117
    v_add_f32 v66, v66, v118
    v_add_f32 v67, v67, v119
    s_nop 1
    v_permlane32_swap_b32 v64, v65
    s_nop 1
    v_add_f32 v64, v64, v65
    s_nop 1
    v_permlane32_swap_b32 v66, v67
    s_nop 1
    v_add_f32 v66, v66, v67
    s_nop 1
    v_permlane16_swap_b32 v64, v66
    s_nop 1
    v_add_f32 v64, v64, v66
    v_and_b32 v19, 1, v9
    v_lshrrev_b32 v20, 1, v9
    v_lshl_add_u32 v19, v19, 1, v20
    v_lshl_add_u32 v19, v8, 2, v19
    v_lshlrev_b32 v19, 2, v19
    s_lshl_b32 s67, s66, 8
    v_add_u32 v19, s67, v19
    ds_write_b32 v19, v64 offset:512
K2_H_NOCONS0:
    s_lshr_b32 s67, s73, 6
    s_cmp_lg_u32 s67, s61
    s_cbranch_scc1 K2_H_NOCONS1
    s_lshr_b32 s67, s62, 1
    s_lshl_b32 s67, s67, 10
    s_mul_i32 s74, s66, 224
    s_add_u32 s67, s67, s74
    s_add_u32 s67, s67, 0x226000
    v_lshlrev_b32 v18, 2, v1
    s_mov_b32 s76, 0x40000
    s_mov_b32 exec_hi, 0x00ffffff
K2_H_SPIN2_1:
    buffer_load_dword v19, v18, s[44:47], s67 offen sc1
    s_waitcnt vmcnt(0)
    v_cmp_ne_u32 vcc, s80, v19
    s_cmp_eq_u64 vcc, 0
    s_cbranch_scc1 K2_H_SPIN2_DONE1
    s_sleep 8
    s_sub_u32 s76, s76, 1
    s_cmp_lg_u32 s76, 0
    s_cbranch_scc1 K2_H_SPIN2_1
K2_H_SPIN2_DONE1:
    s_mov_b64 exec, -1
    v_lshlrev_b32 v18, 12, v9
    v_lshl_add_u32 v18, v8, 4, v18
    s_mul_i32 s67, s66, 229376
    s_lshl_b32 s74, s62, 8
    s_add_u32 s67, s67, s74
    s_add_u32 s67, s67, 0x500800
    buffer_load_dwordx4 v[64:67], v18, s[44:47], s67 offen sc1
    s_add_u32 s67, s67, 16384
    buffer_load_dwordx4 v[68:71], v18, s[44:47], s67 offen sc1
    s_add_u32 s67, s67, 16384
    buffer_load_dwordx4 v[72:75], v18, s[44:47], s67 offen sc1
    s_add_u32 s67, s67, 16384
    buffer_load_dwordx4 v[76:79], v18, s[44:47], s67 offen sc1
    s_add_u32 s67, s67, 16384
    buffer_load_dwordx4 v[80:83], v18, s[44:47], s67 offen sc1
    s_add_u32 s67, s67, 16384
    buffer_load_dwordx4 v[84:87], v18, s[44:47], s67 offen sc1
    s_add_u32 s67, s67, 16384
    buffer_load_dwordx4 v[88:91], v18, s[44:47], s67 offen sc1
    s_add_u32 s67, s67, 16384
    buffer_load_dwordx4 v[92:95], v18, s[44:47], s67 offen sc1
    s_add_u32 s67, s67, 16384
    buffer_load_dwordx4 v[96:99], v18, s[44:47], s67 offen sc1
    s_add_u32 s67, s67, 16384
    buffer_load_dwordx4 v[100:103], v18, s[44:47], s67 offen sc1
    s_add_u32 s67, s67, 16384
    buffer_load_dwordx4 v[104:107], v18, s[44:47], s67 offen sc1
    s_add_u32 s67, s67, 16384
    buffer_load_dwordx4 v[108:111], v18, s[44:47], s67 offen sc1
    s_add_u32 s67, s67, 16384
    buffer_load_dwordx4 v[112:115], v18, s[44:47], s67 offen sc1
    s_add_u32 s67, s67, 16384
    buffer_load_dwordx4 v[116:119], v18, s[44:47], s67 offen sc1
    s_add_u32 s67, s67, 16384
    s_waitcnt vmcnt(0)
    v_add_f32 v64, v64, v68
    v_add_f32 v65, v65, v69
    v_add_f32 v66, v66, v70
    v_add_f32 v67, v67, v71
    v_add_f32 v64, v64, v72
    v_add_f32 v65, v65, v73
    v_add_f32 v66, v66, v74
    v_add_f32 v67, v67, v75
    v_add_f32 v64, v64, v76
    v_add_f32 v65, v65, v77
    v_add_f32 v66, v66, v78
    v_add_f32 v67, v67, v79
    v_add_f32 v64, v64, v80
    v_add_f32 v65, v65, v81
    v_add_f32 v66, v66, v82
    v_add_f32 v67, v67, v83
    v_add_f32 v64, v64, v84
    v_add_f32 v65, v65, v85
    v_add_f32 v66, v66, v86
    v_add_f32 v67, v67, v87
    v_add_f32 v64, v64, v88
    v_add_f32 v65, v65, v89
    v_add_f32 v66, v66, v90
    v_add_f32 v67, v67, v91
    v_add_f32 v64, v64, v92
    v_add_f32 v65, v65, v93
    v_add_f32 v66, v66, v94
    v_add_f32 v67, v67, v95
    v_add_f32 v64, v64, v96
    v_add_f32 v65, v65, v97
    v_add_f32 v66, v66, v98
    v_add_f32 v67, v67, v99
    v_add_f32 v64, v64, v100
    v_add_f32 v65, v65, v101
    v_add_f32 v66, v66, v102
    v_add_f32 v67, v67, v103
    v_add_f32 v64, v64, v104
    v_add_f32 v65, v65, v105
    v_add_f32 v66, v66, v106
    v_add_f32 v67, v67, v107
    v_add_f32 v64, v64, v108
    v_add_f32 v65, v65, v109
    v_add_f32 v66, v66, v110
    v_add_f32 v67, v67, v111
    v_add_f32 v64, v64, v112
    v_add_f32 v65, v65, v113
    v_add_f32 v66, v66, v114
    v_add_f32 v67, v67, v115
    v_add_f32 v64, v64, v116
    v_add_f32 v65, v65, v117
    v_add_f32 v66, v66, v118
    v_add_f32 v67, v67, v119
    s_nop 1
    v_permlane32_swap_b32 v64, v65
    s_nop 1
    v_add_f32 v64, v64, v65
    s_nop 1
    v_permlane32_swap_b32 v66, v67
    s_nop 1
    v_add_f32 v66, v66, v67
    s_nop 1
    v_permlane16_swap_b32 v64, v66
    s_nop 1
    v_add_f32 v64, v64, v66
    v_and_b32 v19, 1, v9
    v_lshrrev_b32 v20, 1, v9
    v_lshl_add_u32 v19, v19, 1, v20
    v_lshl_add_u32 v19, v8, 2, v19
    v_lshlrev_b32 v19, 2, v19
    s_lshl_b32 s67, s66, 8
    v_add_u32 v19, s67, v19
    ds_write_b32 v19, v64 offset:1536
K2_H_NOCONS1:
    s_lshl_b32 s67, s61, 7
    s_add_u32 s67, s67, 0x2b8000
    v_lshlrev_b32 v18, 2, v2
    s_mov_b32 s76, 0x40000
K2_H_SPINI:
    buffer_load_dword v19, v18, s[44:47], s67 offen sc1
    s_waitcnt vmcnt(0)
    v_cmp_ne_u32 vcc, s80, v19
    s_cmp_eq_u64 vcc, 0
    s_cbranch_scc1 K2_H_SPINI_DONE
    s_sleep 8
    s_sub_u32 s76, s76, 1
    s_cmp_lg_u32 s76, 0
    s_cbranch_scc1 K2_H_SPINI
K2_H_SPINI_DONE:
    v_mov_b32 v2, v14
    v_add_u32 v3, s65, v4
    v_mov_b32 v72, 0
    v_mov_b32 v73, 0
    v_mov_b32 v74, 0
    v_mov_b32 v75, 0
    v_mov_b32 v76, 0
    v_mov_b32 v77, 0
    v_mov_b32 v78, 0
    v_mov_b32 v79, 0
    v_mov_b32 v80, 0
    v_mov_b32 v81, 0
    v_mov_b32 v82, 0
    v_mov_b32 v83, 0
    v_mov_b32 v84, 0
    v_mov_b32 v85, 0
    v_mov_b32 v86, 0
    v_mov_b32 v87, 0
    v_mov_b32 v88, 0
    v_mov_b32 v89, 0
    v_mov_b32 v90, 0
    v_mov_b32 v91, 0
    v_mov_b32 v92, 0
    v_mov_b32 v93, 0
    v_mov_b32 v94, 0
    v_mov_b32 v95, 0
    v_mov_b32 v96, 0
    v_mov_b32 v97, 0
    v_mov_b32 v98, 0
    v_mov_b32 v99, 0
    v_mov_b32 v100, 0
    v_mov_b32 v101, 0
    v_mov_b32 v102, 0
    v_mov_b32 v103, 0
    s_waitcnt vmcnt(0) lgkmcnt(0)
    s_setprio 0
    s_branch K2_BAR1
K2_H2:
    s_lshl_b32 s68, s75, 15
    s_lshl_b32 s67, s77, 14
    s_add_u32 s68, s68, s67
    s_add_u32 s68, s68, 0x300000
    s_mov_b32 s76, 0x10000
    s_mov_b32 s74, 0
    s_mov_b32 s71, s68
K2_H_POLL:
    s_bitcmp1_b32 s74, 0
    s_cbranch_scc1 K2_H_NL0
    s_add_u32 s67, s71, 0
    buffer_load_dwordx4 v[8:11], v4, s[44:47], s67 offen offset:0 sc1
    buffer_load_dwordx4 v[12:15], v4, s[44:47], s67 offen offset:1024 sc1
    buffer_load_dwordx4 v[16:19], v4, s[44:47], s67 offen offset:2048 sc1
    buffer_load_dwordx4 v[20:23], v4, s[44:47], s67 offen offset:3072 sc1
K2_H_NL0:
    s_bitcmp1_b32 s74, 1
    s_cbranch_scc1 K2_H_NL1
    s_add_u32 s67, s71, 4096
    buffer_load_dwordx4 v[24:27], v4, s[44:47], s67 offen offset:0 sc1
    buffer_load_dwordx4 v[28:31], v4, s[44:47], s67 offen offset:1024 sc1
    buffer_load_dwordx4 v[32:35], v4, s[44:47], s67 offen offset:2048 sc1
    buffer_load_dwordx4 v[36:39], v4, s[44:47], s67 offen offset:3072 sc1
K2_H_NL1:
    s_bitcmp1_b32 s74, 2
    s_cbranch_scc1 K2_H_NL2
    s_add_u32 s67, s71, 8192
    buffer_load_dwordx4 v[40:43], v4, s[44:47], s67 offen offset:0 sc1
    buffer_load_dwordx4 v[44:47], v4, s[44:47], s67 offen offset:1024 sc1
    buffer_load_dwordx4 v[48:51], v4, s[44:47], s67 offen offset:2048 sc1
    buffer_load_dwordx4 v[52:55], v4, s[44:47], s67 offen offset:3072 sc1
K2_H_NL2:
    s_bitcmp1_b32 s74, 3
    s_cbranch_scc1 K2_H_NL3
    s_add_u32 s67, s71, 12288
    buffer_load_dwordx4 v[56:59], v4, s[44:47], s67 offen offset:0 sc1
    buffer_load_dwordx4 v[60:63], v4, s[44:47], s67 offen offset:1024 sc1
    buffer_load_dwordx4 v[64:67], v4, s[44:47], s67 offen offset:2048 sc1
    buffer_load_dwordx4 v[68:71], v4, s[44:47], s67 offen offset:3072 sc1
K2_H_NL3:
K2_H_CHECK:
    s_waitcnt vmcnt(0)
    s_bitcmp1_b32 s74, 0
    s_cbranch_scc1 K2_H_NC0
    v_max3_u32 v6, v8, v9, v10
    v_max3_u32 v6, v11, v12, v6
    v_max3_u32 v6, v13, v14, v6
    v_max3_u32 v6, v15, v16, v6
    v_max3_u32 v6, v17, v18, v6
    v_max3_u32 v6, v19, v20, v6
    v_max3_u32 v6, v21, v22, v6
    v_max_u32 v6, v23, v6
    v_cmp_eq_u32 vcc, -1, v6
    s_cmp_eq_u32 s76, 1
    s_cselect_b64 vcc, 0, vcc
    s_cmp_eq_u64 vcc, 0
    s_cbranch_scc0 K2_H_NC0
    v_mfma_f32_32x32x16_bf16 v[72:87], v[128:131], v[8:11], v[72:87]
    v_mfma_f32_32x32x16_bf16 v[88:103], v[132:135], v[8:11], v[88:103]
    v_mfma_f32_32x32x16_bf16 v[72:87], v[136:139], v[12:15], v[72:87]
    v_mfma_f32_32x32x16_bf16 v[88:103], v[140:143], v[12:15], v[88:103]
    v_mfma_f32_32x32x16_bf16 v[72:87], v[144:147], v[16:19], v[72:87]
    v_mfma_f32_32x32x16_bf16 v[88:103], v[148:151], v[16:19], v[88:103]
    v_mfma_f32_32x32x16_bf16 v[72:87], v[152:155], v[20:23], v[72:87]
    v_mfma_f32_32x32x16_bf16 v[88:103], v[156:159], v[20:23], v[88:103]
    s_bitset1_b32 s74, 0
K2_H_NC0:
    s_bitcmp1_b32 s74, 1
    s_cbranch_scc1 K2_H_NC1
    v_max3_u32 v6, v24, v25, v26
    v_max3_u32 v6, v27, v28, v6
    v_max3_u32 v6, v29, v30, v6
    v_max3_u32 v6, v31, v32, v6
    v_max3_u32 v6, v33, v34, v6
    v_max3_u32 v6, v35, v36, v6
    v_max3_u32 v6, v37, v38, v6
    v_max_u32 v6, v39, v6
    v_cmp_eq_u32 vcc, -1, v6
    s_cmp_eq_u32 s76, 1
    s_cselect_b64 vcc, 0, vcc
    s_cmp_eq_u64 vcc, 0
    s_cbranch_scc0 K2_H_NC1
    v_mfma_f32_32x32x16_bf16 v[72:87], v[160:163], v[24:27], v[72:87]
    v_mfma_f32_32x32x16_bf16 v[88:103], v[164:167], v[24:27], v[88:103]
    v_mfma_f32_32x32x16_bf16 v[72:87], v[168:171], v[28:31], v[72:87]
    v_mfma_f32_32x32x16_bf16 v[88:103], v[172:175], v[28:31], v[88:103]
    v_mfma_f32_32x32x16_bf16 v[72:87], v[176:179], v[32:35], v[72:87]
    v_mfma_f32_32x32x16_bf16 v[88:103], v[180:183], v[32:35], v[88:103]
    v_mfma_f32_32x32x16_bf16 v[72:87], v[184:187], v[36:39], v[72:87]
    v_mfma_f32_32x32x16_bf16 v[88:103], v[188:191], v[36:39], v[88:103]
    s_bitset1_b32 s74, 1
K2_H_NC1:
    s_bitcmp1_b32 s74, 2
    s_cbranch_scc1 K2_H_NC2
    v_max3_u32 v6, v40, v41, v42
    v_max3_u32 v6, v43, v44, v6
    v_max3_u32 v6, v45, v46, v6
    v_max3_u32 v6, v47, v48, v6
    v_max3_u32 v6, v49, v50, v6
    v_max3_u32 v6, v51, v52, v6
    v_max3_u32 v6, v53, v54, v6
    v_max_u32 v6, v55, v6
    v_cmp_eq_u32 vcc, -1, v6
    s_cmp_eq_u32 s76, 1
    s_cselect_b64 vcc, 0, vcc
    s_cmp_eq_u64 vcc, 0
    s_cbranch_scc0 K2_H_NC2
    v_mfma_f32_32x32x16_bf16 v[72:87], v[192:195], v[40:43], v[72:87]
    v_mfma_f32_32x32x16_bf16 v[88:103], v[196:199], v[40:43], v[88:103]
    v_mfma_f32_32x32x16_bf16 v[72:87], v[200:203], v[44:47], v[72:87]
    v_mfma_f32_32x32x16_bf16 v[88:103], v[204:207], v[44:47], v[88:103]
    v_mfma_f32_32x32x16_bf16 v[72:87], v[208:211], v[48:51], v[72:87]
    v_mfma_f32_32x32x16_bf16 v[88:103], v[212:215], v[48:51], v[88:103]
    v_mfma_f32_32x32x16_bf16 v[72:87], v[216:219], v[52:55], v[72:87]
    v_mfma_f32_32x32x16_bf16 v[88:103], v[220:223], v[52:55], v[88:103]
    s_bitset1_b32 s74, 2
K2_H_NC2:
    s_bitcmp1_b32 s74, 3
    s_cbranch_scc1 K2_H_NC3
    v_max3_u32 v6, v56, v57, v58
    v_max3_u32 v6, v59, v60, v6
    v_max3_u32 v6, v61, v62, v6
    v_max3_u32 v6, v63, v64, v6
    v_max3_u32 v6, v65, v66, v6
    v_max3_u32 v6, v67, v68, v6
    v_max3_u32 v6, v69, v70, v6
    v_max_u32 v6, v71, v6
    v_cmp_eq_u32 vcc, -1, v6
    s_cmp_eq_u32 s76, 1
    s_cselect_b64 vcc, 0, vcc
    s_cmp_eq_u64 vcc, 0
    s_cbranch_scc0 K2_H_NC3
    v_mfma_f32_32x32x16_bf16 v[72:87], v[224:227], v[56:59], v[72:87]
    v_mfma_f32_32x32x16_bf16 v[88:103], v[228:231], v[56:59], v[88:103]
    v_mfma_f32_32x32x16_bf16 v[72:87], v[232:235], v[60:63], v[72:87]
    v_mfma_f32_32x32x16_bf16 v[88:103], v[236:239], v[60:63], v[88:103]
    v_mfma_f32_32x32x16_bf16 v[72:87], v[240:243], v[64:67], v[72:87]
    v_mfma_f32_32x32x16_bf16 v[88:103], v[244:247], v[64:67], v[88:103]
    v_mfma_f32_32x32x16_bf16 v[72:87], v[248:251], v[68:71], v[72:87]
    v_mfma_f32_32x32x16_bf16 v[88:103], v[252:255], v[68:71], v[88:103]
    s_bitset1_b32 s74, 3
K2_H_NC3:
    s_sub_u32 s76, s76, 1
    s_and_b32 s67, s76, 1
    s_cmp_gt_u32 s76, 65528
    s_cselect_b32 s67, 0, s67
    s_mul_i32 s67, s67, 3145728
    s_add_u32 s71, s68, s67
    s_cmp_lg_u32 s74, 15
    s_cbranch_scc1 K2_H_POLL
    s_lshl_b32 s67, s66, 12
    s_add_u32 s67, s67, 32768
    v_add_u32 v6, s67, v4
    s_xor_b32 s67, s67, 4096
    v_add_u32 v7, s67, v4
    v_lshlrev_b32 v8, 16, v120
    v_and_b32 v9, 0xffff0000, v120
    v_lshlrev_b32 v10, 16, v121
    v_and_b32 v11, 0xffff0000, v121
    v_lshlrev_b32 v12, 16, v122
    v_and_b32 v13, 0xffff0000, v122
    v_lshlrev_b32 v14, 16, v123
    v_and_b32 v15, 0xffff0000, v123
    v_lshlrev_b32 v16, 16, v124
    v_and_b32 v17, 0xffff0000, v124
    v_lshlrev_b32 v18, 16, v125
    v_and_b32 v19, 0xffff0000, v125
    v_lshlrev_b32 v20, 16, v126
    v_and_b32 v21, 0xffff0000, v126
    v_lshlrev_b32 v22, 16, v127
    v_and_b32 v23, 0xffff0000, v127
    ds_write_b128 v6, v[88:91] offset:0
    ds_write_b128 v6, v[92:95] offset:1024
    ds_write_b128 v6, v[96:99] offset:2048
    ds_write_b128 v6, v[100:103] offset:3072
    s_waitcnt lgkmcnt(0)
    s_barrier
    ds_read_b128 v[24:27], v7 offset:0
    ds_read_b128 v[104:107], v3 offset:0
    ds_read_b128 v[28:31], v7 offset:1024
    ds_read_b128 v[108:111], v3 offset:1024
    ds_read_b128 v[32:35], v7 offset:2048
    ds_read_b128 v[112:115], v3 offset:2048
    ds_read_b128 v[36:39], v7 offset:3072
    ds_read_b128 v[116:119], v3 offset:3072
    s_waitcnt lgkmcnt(0)
    v_add_f32 v24, v24, v72
    v_fma_f32 v8, v24, v104, v8
    v_add_f32 v25, v25, v73
    v_fma_f32 v9, v25, v105, v9
    v_cvt_pk_bf16_f32 v40, v8, v9
    v_add_f32 v26, v26, v74
    v_fma_f32 v10, v26, v106, v10
    v_add_f32 v27, v27, v75
    v_fma_f32 v11, v27, v107, v11
    v_cvt_pk_bf16_f32 v41, v10, v11
    v_add_f32 v28, v28, v76
    v_fma_f32 v12, v28, v108, v12
    v_add_f32 v29, v29, v77
    v_fma_f32 v13, v29, v109, v13
    v_cvt_pk_bf16_f32 v42, v12, v13
    v_add_f32 v30, v30, v78
    v_fma_f32 v14, v30, v110, v14
    v_add_f32 v31, v31, v79
    v_fma_f32 v15, v31, v111, v15
    v_cvt_pk_bf16_f32 v43, v14, v15
    v_add_f32 v32, v32, v80
    v_fma_f32 v16, v32, v112, v16
    v_add_f32 v33, v33, v81
    v_fma_f32 v17, v33, v113, v17
    v_cvt_pk_bf16_f32 v44, v16, v17
    v_add_f32 v34, v34, v82
    v_fma_f32 v18, v34, v114, v18
    v_add_f32 v35, v35, v83
    v_fma_f32 v19, v35, v115, v19
    v_cvt_pk_bf16_f32 v45, v18, v19
    v_add_f32 v36, v36, v84
    v_fma_f32 v20, v36, v116, v20
    v_add_f32 v37, v37, v85
    v_fma_f32 v21, v37, v117, v21
    v_cvt_pk_bf16_f32 v46, v20, v21
    v_add_f32 v38, v38, v86
    v_fma_f32 v22, v38, v118, v22
    v_add_f32 v39, v39, v87
    v_fma_f32 v23, v39, v119, v23
    v_cvt_pk_bf16_f32 v47, v22, v23
    buffer_store_dwordx4 v[40:43], v2, s[40:43], s58 offen
    buffer_store_dwordx4 v[44:47], v2, s[40:43], s58 offen offset:16
K2_END:
    s_endpgm
.section .rodata,"a"
.p2align 6
.amdhsa_kernel recurrent_scan__grouped_kv_mqa__moe_arch_mod__prompt_kernel
  .amdhsa_next_free_vgpr 256
  .amdhsa_next_free_sgpr 102
  .amdhsa_accum_offset 256
  .amdhsa_group_segment_fixed_size 0
  .amdhsa_kernarg_size 104
  .amdhsa_user_sgpr_count 2
  .amdhsa_user_sgpr_kernarg_segment_ptr 1
  .amdhsa_system_sgpr_workgroup_id_x 1
  .amdhsa_float_denorm_mode_32 3
.end_amdhsa_kernel
```
